```python
import torch

def _softmax(x, axis=-1):
    return torch.softmax(x, dim=axis)
def _gelu(x):
    return torch.nn.functional.gelu(x, approximate="tanh")
def _silu(x):
    return torch.nn.functional.silu(x)
def _sigmoid(x):
    return torch.sigmoid(x)
def _layernorm(x, axis=-1, eps=1e-5):
    m = x.mean(dim=axis, keepdim=True)
    v = x.var(dim=axis, keepdim=True, unbiased=False)
    return (x - m) / torch.sqrt(v + eps)
def _scatter_add(tgt, idx, src, axis=0):
    return tgt.clone().index_add_(axis, idx, src)
def _segment_sum(src, seg, n):
    out = torch.zeros((n,) + src.shape[1:], dtype=src.dtype)
    return out.index_add_(0, seg, src)
def _pad(x, pw):
    flat = tuple(v for pair in reversed(pw) for v in pair)
    return torch.nn.functional.pad(x, flat)

kernel_name = 'gated_mix__mha_block_cached__geglu_ffn__decode'

def setup_inputs():

    _w = (lambda a: (lambda t: t.to(torch.bfloat16) if t.is_floating_point() else t)(torch.as_tensor(a)))
    def _A_setup():
        B, Sq, D = 8, 1, 1024
        H, Sk, Dh = 32, 4096, 128
        return {
            "x": _w((lambda *s: torch.randn(*s, dtype=torch.bfloat16) * 0.05)(B, Sq, D)),
            "k_cache": _w((lambda *s: torch.randn(*s, dtype=torch.bfloat16) * 6.4)(B, H, Sk, Dh)),
            "v_cache": _w((lambda *s: torch.randn(*s, dtype=torch.bfloat16) * 0.4)(B, H, Sk, Dh)),
            "wq": _w((lambda *s: torch.randn(*s, dtype=torch.bfloat16) * 6.4)(D, H * Dh) * (D ** -0.5)),
            "wo": _w((lambda *s: torch.randn(*s, dtype=torch.bfloat16) * 0.4)(H * Dh, D) * ((H * Dh) ** -0.5)),
        }
    _A_in = _A_setup()

    def _B_setup():
        B, S, D, F = 8, 1, 1024, 3584
        return {
            "x": _w((lambda *s: torch.randn(*s, dtype=torch.bfloat16) * 0.05)(B, S, D)),
            "w_gate": _w((lambda *s: torch.randn(*s, dtype=torch.bfloat16) * 0.05)(D, F)),
            "w_up": _w((lambda *s: torch.randn(*s, dtype=torch.bfloat16) * 0.05)(D, F)),
            "w_down": _w((lambda *s: torch.randn(*s, dtype=torch.bfloat16) * 0.05)(F, D)),
        }
    _B_in = _B_setup()

    return {
        "A_x": _A_in["x"],
        "A_k_cache": _A_in["k_cache"],
        "A_v_cache": _A_in["v_cache"],
        "A_wq": _A_in["wq"],
        "A_wo": _A_in["wo"],
        "B_x": _B_in["x"],
        "B_w_gate": _B_in["w_gate"],
        "B_w_up": _B_in["w_up"],
        "B_w_down": _B_in["w_down"],
        "gate_w": _w((lambda *s: torch.randn(*s, dtype=torch.bfloat16) * 0.05)(1024) * 16.0),
    }

def reference(A_x, A_k_cache, A_v_cache, A_wq, A_wo, B_x, B_w_gate, B_w_up, B_w_down, gate_w):
    def _A_ref(x, k_cache, v_cache, wq, wo):
        B, Sq, D = x.shape
        H, Dh = 32, 128
        q = (lambda x, *d: x.permute(*d))((x @ wq).reshape(B, Sq, H, Dh), 0, 2, 1, 3)
        scores = torch.einsum("bhqd,bhkd->bhqk", q, k_cache) * (Dh ** -0.5)
        p = _softmax(scores, axis=-1)
        o = torch.einsum("bhqk,bhkd->bhqd", p, v_cache)
        return (lambda x, *d: x.permute(*d))(o, 0, 2, 1, 3).reshape(B, Sq, H * Dh) @ wo

    def _B_ref(x, w_gate, w_up, w_down):
        return (_gelu(x @ w_gate) * (x @ w_up)) @ w_down

    x = A_x
    g = _sigmoid((x * gate_w).sum(-1, keepdims=True))
    a = _A_ref(x, A_k_cache, A_v_cache, A_wq, A_wo)
    b = _B_ref(x, B_w_gate, B_w_up, B_w_down)
    return g * a + (1 - g) * b
```

```asm
; @launch grid=(256,1,1) block=(384,1,1) lds=161792
.amdgcn_target "amdgcn-amd-amdhsa--gfx950"
.text
.globl gated_mix__mha_block_cached__geglu_ffn__decode_kernel
.p2align 8
.type gated_mix__mha_block_cached__geglu_ffn__decode_kernel,@function
gated_mix__mha_block_cached__geglu_ffn__decode_kernel:
    s_cmp_ge_u32 s2, 256
    s_cbranch_scc1 L_end
    s_load_dwordx16 s[8:23], s[0:1], 0
    s_load_dwordx8 s[24:31], s[0:1], 64
    s_load_dwordx2 s[32:33], s[0:1], 96
    v_lshrrev_b32 v1, 6, v0
    s_nop 0
    v_readfirstlane_b32 s3, v1
    v_and_b32 v0, 63, v0
    s_lshr_b32 s4, s2, 5
    s_and_b32 s5, s2, 31
    s_mov_b32 s60, 0xff00ff00
    s_mov_b32 s61, 0xff00ff00
    s_mov_b32 s62, 0xcccccccc
    s_mov_b32 s63, 0xcccccccc
    s_mov_b32 s64, 0xaaaaaaaa
    s_mov_b32 s65, 0xaaaaaaaa
    s_mov_b32 s68, 0x3fb8aa3b
    s_waitcnt lgkmcnt(0)
    s_mov_b32 s36, s32
    s_and_b32 s37, s33, 0xffff
    s_mov_b32 s38, 16777216
    s_mov_b32 s39, 0x20000
    s_cmp_eq_u32 s3, 4
    s_cbranch_scc1 L_aux0
    s_cmp_eq_u32 s3, 5
    s_cbranch_scc1 L_aux1
    s_mov_b32 s40, s10
    s_and_b32 s41, s11, 0xffff
    s_mov_b32 s42, 268435456
    s_mov_b32 s43, 0x20000
    s_mov_b32 s44, s12
    s_and_b32 s45, s13, 0xffff
    s_mov_b32 s46, 268435456
    s_mov_b32 s47, 0x20000
    v_lshlrev_b32 v1, 4, v0
    s_lshl_b32 s34, s2, 20
    s_lshl_b32 s57, s3, 13
    s_add_u32 s34, s34, s57
    s_mov_b32 s69, s34
    buffer_load_dword v31, off, s[36:39], 0 offset:0 sc1
    s_mov_b32 s48, s16
    s_and_b32 s49, s17, 0xffff
    s_mov_b32 s50, 8388608
    s_mov_b32 s51, 0x20000
    buffer_load_dwordx4 v[48:51], v1, s[40:43], s69 offen offset:0 nt
    buffer_load_dwordx4 v[52:55], v1, s[40:43], s69 offen offset:1024 nt
    s_barrier
    v_and_b32 v5, 15, v0
    v_lshrrev_b32 v5, 1, v5
    v_mov_b32 v6, 0xffff
    v_mov_b32 v7, 0xffff0000
    v_cndmask_b32 v7, v6, v7, s[64:65]
    v_cmp_eq_u32 vcc, 0, v5
    s_nop 1
    v_cndmask_b32_e64 v16, 0, v7, vcc
    v_cmp_eq_u32 vcc, 1, v5
    s_nop 1
    v_cndmask_b32_e64 v17, 0, v7, vcc
    v_cmp_eq_u32 vcc, 2, v5
    s_nop 1
    v_cndmask_b32_e64 v18, 0, v7, vcc
    v_cmp_eq_u32 vcc, 3, v5
    s_nop 1
    v_cndmask_b32_e64 v19, 0, v7, vcc
    v_mov_b32 v2, 0xff800000
    v_mov_b32 v3, 0
    v_mov_b32 v8, 0
    v_mov_b32 v9, 0
    v_mov_b32 v10, 0
    v_mov_b32 v11, 0
    v_bfe_u32 v5, v0, 4, 1
    v_lshlrev_b32 v5, 1, v5
    v_and_b32 v6, 7, v0
    v_xor_b32 v6, v5, v6
    v_lshlrev_b32 v6, 4, v6
    v_lshrrev_b32 v5, 3, v0
    s_mov_b32 s57, 2048
    v_mul_lo_u32 v5, v5, s57
    v_add_u32 v176, v5, v6
    v_xor_b32 v6, 64, v6
    v_add_u32 v177, v5, v6
    v_lshrrev_b32 v5, 4, v0
    v_bfe_u32 v6, v0, 2, 2
    v_lshl_add_u32 v178, v5, 3, v6
    v_lshlrev_b32 v178, 7, v178
    v_bfe_u32 v5, v0, 3, 2
    v_lshl_add_u32 v178, v5, 5, v178
    v_and_b32 v5, 3, v0
    v_lshl_add_u32 v178, v5, 3, v178
    s_lshl_b32 s57, s3, 5
    v_xor_b32 v178, s57, v178
    v_and_b32 v5, 7, v0
    v_mul_u32_u24 v179, 272, v5
    v_lshrrev_b32 v5, 4, v0
    v_lshl_add_u32 v179, v5, 4, v179
    v_add_u32 v179, 103424, v179
    v_and_b32 v180, 7, v0
    v_lshlrev_b32 v180, 8, v180
    v_lshl_add_u32 v180, v5, 4, v180
    v_mov_b32 v181, 0xffffff00
    s_lshl_b32 s57, s3, 12
    s_add_u32 s70, s57, 112640
    v_lshl_add_u32 v182, v0, 2, s70
    s_mov_b32 s71, 0x3db504f3
    s_waitcnt vmcnt(1)
    buffer_load_dwordx4 v[56:59], v1, s[40:43], s69 offen offset:2048 nt
    s_waitcnt vmcnt(1)
    buffer_load_dwordx4 v[60:63], v1, s[40:43], s69 offen offset:3072 nt
    s_waitcnt vmcnt(1)
    s_add_u32 s35, s69, 4096
    buffer_load_dwordx4 v[64:67], v1, s[40:43], s35 offen offset:0 nt
    s_waitcnt vmcnt(1)
    s_add_u32 s35, s69, 4096
    buffer_load_dwordx4 v[68:71], v1, s[40:43], s35 offen offset:1024 nt
    s_waitcnt vmcnt(1)
    s_add_u32 s35, s69, 4096
    buffer_load_dwordx4 v[72:75], v1, s[40:43], s35 offen offset:2048 nt
    s_waitcnt vmcnt(1)
    s_add_u32 s35, s69, 4096
    buffer_load_dwordx4 v[76:79], v1, s[40:43], s35 offen offset:3072 nt
    s_waitcnt vmcnt(1)
    s_add_u32 s35, s69, 32768
    buffer_load_dwordx4 v[80:83], v1, s[40:43], s35 offen offset:0 nt
    s_waitcnt vmcnt(1)
    s_add_u32 s35, s69, 32768
    buffer_load_dwordx4 v[84:87], v1, s[40:43], s35 offen offset:1024 nt
    s_waitcnt vmcnt(4)
    s_add_u32 s35, s69, 32768
    buffer_load_dwordx4 v[88:91], v1, s[40:43], s35 offen offset:2048 nt
    s_waitcnt vmcnt(4)
    s_add_u32 s35, s69, 32768
    buffer_load_dwordx4 v[92:95], v1, s[40:43], s35 offen offset:3072 nt
    s_waitcnt vmcnt(4)
    s_add_u32 s35, s69, 36864
    buffer_load_dwordx4 v[96:99], v1, s[40:43], s35 offen offset:0 nt
    s_waitcnt vmcnt(4)
    s_add_u32 s35, s69, 36864
    buffer_load_dwordx4 v[100:103], v1, s[40:43], s35 offen offset:1024 nt
    s_waitcnt vmcnt(4)
    s_add_u32 s35, s69, 36864
    buffer_load_dwordx4 v[104:107], v1, s[40:43], s35 offen offset:2048 nt
    s_waitcnt vmcnt(4)
    s_add_u32 s35, s69, 36864
    buffer_load_dwordx4 v[108:111], v1, s[40:43], s35 offen offset:3072 nt
    s_waitcnt vmcnt(4)
    s_add_u32 s35, s69, 65536
    buffer_load_dwordx4 v[112:115], v1, s[40:43], s35 offen offset:0 nt
    s_waitcnt vmcnt(4)
    s_add_u32 s35, s69, 65536
    buffer_load_dwordx4 v[116:119], v1, s[40:43], s35 offen offset:1024 nt
    s_waitcnt vmcnt(4)
    s_add_u32 s35, s69, 65536
    buffer_load_dwordx4 v[120:123], v1, s[40:43], s35 offen offset:2048 nt
    s_waitcnt vmcnt(4)
    s_add_u32 s35, s69, 65536
    buffer_load_dwordx4 v[124:127], v1, s[40:43], s35 offen offset:3072 nt
    s_waitcnt vmcnt(4)
    s_add_u32 s35, s69, 69632
    buffer_load_dwordx4 v[128:131], v1, s[40:43], s35 offen offset:0 nt
    s_waitcnt vmcnt(4)
    s_add_u32 s35, s69, 69632
    buffer_load_dwordx4 v[132:135], v1, s[40:43], s35 offen offset:1024 nt
    s_waitcnt vmcnt(4)
    s_add_u32 s35, s69, 69632
    buffer_load_dwordx4 v[136:139], v1, s[40:43], s35 offen offset:2048 nt
    s_waitcnt vmcnt(4)
    s_add_u32 s35, s69, 69632
    buffer_load_dwordx4 v[140:143], v1, s[40:43], s35 offen offset:3072 nt
    s_waitcnt vmcnt(4)
    s_add_u32 s35, s69, 98304
    buffer_load_dwordx4 v[144:147], v1, s[40:43], s35 offen offset:0 nt
    s_waitcnt vmcnt(4)
    s_add_u32 s35, s69, 98304
    buffer_load_dwordx4 v[148:151], v1, s[40:43], s35 offen offset:1024 nt
    s_waitcnt vmcnt(4)
    s_add_u32 s35, s69, 98304
    buffer_load_dwordx4 v[152:155], v1, s[40:43], s35 offen offset:2048 nt
    s_waitcnt vmcnt(4)
    s_add_u32 s35, s69, 98304
    buffer_load_dwordx4 v[156:159], v1, s[40:43], s35 offen offset:3072 nt
    s_waitcnt vmcnt(4)
    s_add_u32 s35, s69, 102400
    buffer_load_dwordx4 v[160:163], v1, s[40:43], s35 offen offset:0 nt
    s_waitcnt vmcnt(4)
    s_add_u32 s35, s69, 102400
    buffer_load_dwordx4 v[164:167], v1, s[40:43], s35 offen offset:1024 nt
    s_waitcnt vmcnt(4)
    s_add_u32 s35, s69, 102400
    buffer_load_dwordx4 v[168:171], v1, s[40:43], s35 offen offset:2048 nt
    s_waitcnt vmcnt(4)
    s_add_u32 s35, s69, 102400
    buffer_load_dwordx4 v[172:175], v1, s[40:43], s35 offen offset:3072 nt
    s_waitcnt vmcnt(32)
    v_readfirstlane_b32 s56, v31
    s_nop 0
    s_add_u32 s56, s56, 2654435769
    s_mov_b32 s72, s56
    s_lshr_b32 s73, s56, 8
    s_lshr_b32 s74, s56, 16
    s_lshr_b32 s75, s56, 24
    s_add_u32 s69, s69, 131072
    v_mov_b32 v5, 98560
    s_mov_b32 s58, 3200000
L_qw:
    ds_read_b32 v6, v5
    s_waitcnt lgkmcnt(0)
    v_readfirstlane_b32 s57, v6
    s_nop 0
    s_cmp_lg_u32 s57, 0
    s_cbranch_scc1 L_qk
    s_sub_u32 s58, s58, 1
    s_cmp_eq_u32 s58, 0
    s_cbranch_scc1 L_qk
    s_sleep 1
    s_branch L_qw
L_qk:
    v_and_b32 v5, 15, v0
    v_lshlrev_b32 v5, 4, v5
    v_add_u32 v5, 98304, v5
    ds_read_b128 v[12:15], v5
    s_waitcnt lgkmcnt(0)
    s_mov_b32 s59, 7
L_kloop0:
    s_nop 1
    v_dot2_f32_bf16 v32, v48, v12, 0
    v_dot2_f32_bf16 v32, v49, v13, v32
    v_dot2_f32_bf16 v32, v50, v14, v32
    v_dot2_f32_bf16 v32, v51, v15, v32
    s_waitcnt vmcnt(4)
    buffer_load_dwordx4 v[48:51], v1, s[40:43], s69 offen offset:0 nt
    v_dot2_f32_bf16 v33, v52, v12, 0
    v_dot2_f32_bf16 v33, v53, v13, v33
    v_dot2_f32_bf16 v33, v54, v14, v33
    v_dot2_f32_bf16 v33, v55, v15, v33
    s_waitcnt vmcnt(4)
    buffer_load_dwordx4 v[52:55], v1, s[40:43], s69 offen offset:1024 nt
    v_dot2_f32_bf16 v34, v56, v12, 0
    v_dot2_f32_bf16 v34, v57, v13, v34
    v_dot2_f32_bf16 v34, v58, v14, v34
    v_dot2_f32_bf16 v34, v59, v15, v34
    s_waitcnt vmcnt(4)
    buffer_load_dwordx4 v[56:59], v1, s[40:43], s69 offen offset:2048 nt
    v_dot2_f32_bf16 v35, v60, v12, 0
    v_dot2_f32_bf16 v35, v61, v13, v35
    v_dot2_f32_bf16 v35, v62, v14, v35
    v_dot2_f32_bf16 v35, v63, v15, v35
    s_waitcnt vmcnt(4)
    buffer_load_dwordx4 v[60:63], v1, s[40:43], s69 offen offset:3072 nt
    v_dot2_f32_bf16 v36, v64, v12, 0
    v_dot2_f32_bf16 v36, v65, v13, v36
    v_dot2_f32_bf16 v36, v66, v14, v36
    v_dot2_f32_bf16 v36, v67, v15, v36
    s_waitcnt vmcnt(4)
    s_add_u32 s35, s69, 4096
    buffer_load_dwordx4 v[64:67], v1, s[40:43], s35 offen offset:0 nt
    v_dot2_f32_bf16 v37, v68, v12, 0
    v_dot2_f32_bf16 v37, v69, v13, v37
    v_dot2_f32_bf16 v37, v70, v14, v37
    v_dot2_f32_bf16 v37, v71, v15, v37
    s_waitcnt vmcnt(4)
    s_add_u32 s35, s69, 4096
    buffer_load_dwordx4 v[68:71], v1, s[40:43], s35 offen offset:1024 nt
    v_dot2_f32_bf16 v38, v72, v12, 0
    v_dot2_f32_bf16 v38, v73, v13, v38
    v_dot2_f32_bf16 v38, v74, v14, v38
    v_dot2_f32_bf16 v38, v75, v15, v38
    s_waitcnt vmcnt(4)
    s_add_u32 s35, s69, 4096
    buffer_load_dwordx4 v[72:75], v1, s[40:43], s35 offen offset:2048 nt
    v_dot2_f32_bf16 v39, v76, v12, 0
    v_dot2_f32_bf16 v39, v77, v13, v39
    v_dot2_f32_bf16 v39, v78, v14, v39
    v_dot2_f32_bf16 v39, v79, v15, v39
    s_waitcnt vmcnt(4)
    s_add_u32 s35, s69, 4096
    buffer_load_dwordx4 v[76:79], v1, s[40:43], s35 offen offset:3072 nt
    v_dot2_f32_bf16 v40, v80, v12, 0
    v_dot2_f32_bf16 v40, v81, v13, v40
    v_dot2_f32_bf16 v40, v82, v14, v40
    v_dot2_f32_bf16 v40, v83, v15, v40
    s_waitcnt vmcnt(4)
    s_add_u32 s35, s69, 32768
    buffer_load_dwordx4 v[80:83], v1, s[40:43], s35 offen offset:0 nt
    v_dot2_f32_bf16 v41, v84, v12, 0
    v_dot2_f32_bf16 v41, v85, v13, v41
    v_dot2_f32_bf16 v41, v86, v14, v41
    v_dot2_f32_bf16 v41, v87, v15, v41
    s_waitcnt vmcnt(4)
    s_add_u32 s35, s69, 32768
    buffer_load_dwordx4 v[84:87], v1, s[40:43], s35 offen offset:1024 nt
    v_dot2_f32_bf16 v42, v88, v12, 0
    v_dot2_f32_bf16 v42, v89, v13, v42
    v_dot2_f32_bf16 v42, v90, v14, v42
    v_dot2_f32_bf16 v42, v91, v15, v42
    s_waitcnt vmcnt(4)
    s_add_u32 s35, s69, 32768
    buffer_load_dwordx4 v[88:91], v1, s[40:43], s35 offen offset:2048 nt
    v_dot2_f32_bf16 v43, v92, v12, 0
    v_dot2_f32_bf16 v43, v93, v13, v43
    v_dot2_f32_bf16 v43, v94, v14, v43
    v_dot2_f32_bf16 v43, v95, v15, v43
    s_waitcnt vmcnt(4)
    s_add_u32 s35, s69, 32768
    buffer_load_dwordx4 v[92:95], v1, s[40:43], s35 offen offset:3072 nt
    v_dot2_f32_bf16 v44, v96, v12, 0
    v_dot2_f32_bf16 v44, v97, v13, v44
    v_dot2_f32_bf16 v44, v98, v14, v44
    v_dot2_f32_bf16 v44, v99, v15, v44
    s_waitcnt vmcnt(4)
    s_add_u32 s35, s69, 36864
    buffer_load_dwordx4 v[96:99], v1, s[40:43], s35 offen offset:0 nt
    v_dot2_f32_bf16 v45, v100, v12, 0
    v_dot2_f32_bf16 v45, v101, v13, v45
    v_dot2_f32_bf16 v45, v102, v14, v45
    v_dot2_f32_bf16 v45, v103, v15, v45
    s_waitcnt vmcnt(4)
    s_add_u32 s35, s69, 36864
    buffer_load_dwordx4 v[100:103], v1, s[40:43], s35 offen offset:1024 nt
    v_dot2_f32_bf16 v46, v104, v12, 0
    v_dot2_f32_bf16 v46, v105, v13, v46
    v_dot2_f32_bf16 v46, v106, v14, v46
    v_dot2_f32_bf16 v46, v107, v15, v46
    s_waitcnt vmcnt(4)
    s_add_u32 s35, s69, 36864
    buffer_load_dwordx4 v[104:107], v1, s[40:43], s35 offen offset:2048 nt
    v_dot2_f32_bf16 v47, v108, v12, 0
    v_dot2_f32_bf16 v47, v109, v13, v47
    v_dot2_f32_bf16 v47, v110, v14, v47
    v_dot2_f32_bf16 v47, v111, v15, v47
    s_waitcnt vmcnt(4)
    s_add_u32 s35, s69, 36864
    buffer_load_dwordx4 v[108:111], v1, s[40:43], s35 offen offset:3072 nt
    v_add_f32_dpp v32, v32, v32 row_ror:8 row_mask:0xf bank_mask:0x3
    v_add_f32_dpp v32, v40, v40 row_ror:8 row_mask:0xf bank_mask:0xc
    v_add_f32_dpp v33, v33, v33 row_ror:8 row_mask:0xf bank_mask:0x3
    v_add_f32_dpp v33, v41, v41 row_ror:8 row_mask:0xf bank_mask:0xc
    v_add_f32_dpp v34, v34, v34 row_ror:8 row_mask:0xf bank_mask:0x3
    v_add_f32_dpp v34, v42, v42 row_ror:8 row_mask:0xf bank_mask:0xc
    v_add_f32_dpp v35, v35, v35 row_ror:8 row_mask:0xf bank_mask:0x3
    v_add_f32_dpp v35, v43, v43 row_ror:8 row_mask:0xf bank_mask:0xc
    v_add_f32_dpp v36, v36, v36 row_ror:8 row_mask:0xf bank_mask:0x3
    v_add_f32_dpp v36, v44, v44 row_ror:8 row_mask:0xf bank_mask:0xc
    v_add_f32_dpp v37, v37, v37 row_ror:8 row_mask:0xf bank_mask:0x3
    v_add_f32_dpp v37, v45, v45 row_ror:8 row_mask:0xf bank_mask:0xc
    v_add_f32_dpp v38, v38, v38 row_ror:8 row_mask:0xf bank_mask:0x3
    v_add_f32_dpp v38, v46, v46 row_ror:8 row_mask:0xf bank_mask:0xc
    v_add_f32_dpp v39, v39, v39 row_ror:8 row_mask:0xf bank_mask:0x3
    v_add_f32_dpp v39, v47, v47 row_ror:8 row_mask:0xf bank_mask:0xc
    v_add_f32_dpp v32, v32, v32 row_shl:4 row_mask:0xf bank_mask:0x5
    v_add_f32_dpp v32, v36, v36 row_shr:4 row_mask:0xf bank_mask:0xa
    v_add_f32_dpp v33, v33, v33 row_shl:4 row_mask:0xf bank_mask:0x5
    v_add_f32_dpp v33, v37, v37 row_shr:4 row_mask:0xf bank_mask:0xa
    v_add_f32_dpp v34, v34, v34 row_shl:4 row_mask:0xf bank_mask:0x5
    v_add_f32_dpp v34, v38, v38 row_shr:4 row_mask:0xf bank_mask:0xa
    v_add_f32_dpp v35, v35, v35 row_shl:4 row_mask:0xf bank_mask:0x5
    v_add_f32_dpp v35, v39, v39 row_shr:4 row_mask:0xf bank_mask:0xa
    v_cndmask_b32 v5, v32, v34, s[62:63]
    v_cndmask_b32 v6, v34, v32, s[62:63]
    v_cndmask_b32 v7, v33, v35, s[62:63]
    v_cndmask_b32 v29, v35, v33, s[62:63]
    v_add_f32_dpp v5, v6, v5 quad_perm:[2,3,0,1] row_mask:0xf bank_mask:0xf
    s_nop 0
    v_add_f32_dpp v7, v29, v7 quad_perm:[2,3,0,1] row_mask:0xf bank_mask:0xf
    v_cndmask_b32 v28, v5, v7, s[64:65]
    v_cndmask_b32 v6, v7, v5, s[64:65]
    s_nop 1
    v_add_f32_dpp v28, v6, v28 quad_perm:[1,0,3,2] row_mask:0xf bank_mask:0xf
    v_cvt_pk_bf16_f32 v28, v28, v28
    v_lshlrev_b32 v28, 16, v28
    v_mul_f32 v28, s71, v28
    v_cvt_pk_bf16_f32 v28, v28, v28
    v_lshlrev_b32 v28, 16, v28
    ds_write_b32 v182, v28 offset:0
    v_max_f32 v5, v2, v28
    v_sub_f32 v6, v2, v5
    v_sub_f32 v7, v28, v5
    v_mul_f32 v6, s68, v6
    v_mul_f32 v7, s68, v7
    v_exp_f32 v6, v6
    v_exp_f32 v7, v7
    v_mov_b32 v2, v5
    v_fma_f32 v3, v3, v6, v7
    v_dot2_f32_bf16 v32, v112, v12, 0
    v_dot2_f32_bf16 v32, v113, v13, v32
    v_dot2_f32_bf16 v32, v114, v14, v32
    v_dot2_f32_bf16 v32, v115, v15, v32
    s_waitcnt vmcnt(4)
    s_add_u32 s35, s69, 65536
    buffer_load_dwordx4 v[112:115], v1, s[40:43], s35 offen offset:0 nt
    v_dot2_f32_bf16 v33, v116, v12, 0
    v_dot2_f32_bf16 v33, v117, v13, v33
    v_dot2_f32_bf16 v33, v118, v14, v33
    v_dot2_f32_bf16 v33, v119, v15, v33
    s_waitcnt vmcnt(4)
    s_add_u32 s35, s69, 65536
    buffer_load_dwordx4 v[116:119], v1, s[40:43], s35 offen offset:1024 nt
    v_dot2_f32_bf16 v34, v120, v12, 0
    v_dot2_f32_bf16 v34, v121, v13, v34
    v_dot2_f32_bf16 v34, v122, v14, v34
    v_dot2_f32_bf16 v34, v123, v15, v34
    s_waitcnt vmcnt(4)
    s_add_u32 s35, s69, 65536
    buffer_load_dwordx4 v[120:123], v1, s[40:43], s35 offen offset:2048 nt
    v_dot2_f32_bf16 v35, v124, v12, 0
    v_dot2_f32_bf16 v35, v125, v13, v35
    v_dot2_f32_bf16 v35, v126, v14, v35
    v_dot2_f32_bf16 v35, v127, v15, v35
    s_waitcnt vmcnt(4)
    s_add_u32 s35, s69, 65536
    buffer_load_dwordx4 v[124:127], v1, s[40:43], s35 offen offset:3072 nt
    v_dot2_f32_bf16 v36, v128, v12, 0
    v_dot2_f32_bf16 v36, v129, v13, v36
    v_dot2_f32_bf16 v36, v130, v14, v36
    v_dot2_f32_bf16 v36, v131, v15, v36
    s_waitcnt vmcnt(4)
    s_add_u32 s35, s69, 69632
    buffer_load_dwordx4 v[128:131], v1, s[40:43], s35 offen offset:0 nt
    v_dot2_f32_bf16 v37, v132, v12, 0
    v_dot2_f32_bf16 v37, v133, v13, v37
    v_dot2_f32_bf16 v37, v134, v14, v37
    v_dot2_f32_bf16 v37, v135, v15, v37
    s_waitcnt vmcnt(4)
    s_add_u32 s35, s69, 69632
    buffer_load_dwordx4 v[132:135], v1, s[40:43], s35 offen offset:1024 nt
    v_dot2_f32_bf16 v38, v136, v12, 0
    v_dot2_f32_bf16 v38, v137, v13, v38
    v_dot2_f32_bf16 v38, v138, v14, v38
    v_dot2_f32_bf16 v38, v139, v15, v38
    s_waitcnt vmcnt(4)
    s_add_u32 s35, s69, 69632
    buffer_load_dwordx4 v[136:139], v1, s[40:43], s35 offen offset:2048 nt
    v_dot2_f32_bf16 v39, v140, v12, 0
    v_dot2_f32_bf16 v39, v141, v13, v39
    v_dot2_f32_bf16 v39, v142, v14, v39
    v_dot2_f32_bf16 v39, v143, v15, v39
    s_waitcnt vmcnt(4)
    s_add_u32 s35, s69, 69632
    buffer_load_dwordx4 v[140:143], v1, s[40:43], s35 offen offset:3072 nt
    v_dot2_f32_bf16 v40, v144, v12, 0
    v_dot2_f32_bf16 v40, v145, v13, v40
    v_dot2_f32_bf16 v40, v146, v14, v40
    v_dot2_f32_bf16 v40, v147, v15, v40
    s_waitcnt vmcnt(4)
    s_add_u32 s35, s69, 98304
    buffer_load_dwordx4 v[144:147], v1, s[40:43], s35 offen offset:0 nt
    v_dot2_f32_bf16 v41, v148, v12, 0
    v_dot2_f32_bf16 v41, v149, v13, v41
    v_dot2_f32_bf16 v41, v150, v14, v41
    v_dot2_f32_bf16 v41, v151, v15, v41
    s_waitcnt vmcnt(4)
    s_add_u32 s35, s69, 98304
    buffer_load_dwordx4 v[148:151], v1, s[40:43], s35 offen offset:1024 nt
    v_dot2_f32_bf16 v42, v152, v12, 0
    v_dot2_f32_bf16 v42, v153, v13, v42
    v_dot2_f32_bf16 v42, v154, v14, v42
    v_dot2_f32_bf16 v42, v155, v15, v42
    s_waitcnt vmcnt(4)
    s_add_u32 s35, s69, 98304
    buffer_load_dwordx4 v[152:155], v1, s[40:43], s35 offen offset:2048 nt
    v_dot2_f32_bf16 v43, v156, v12, 0
    v_dot2_f32_bf16 v43, v157, v13, v43
    v_dot2_f32_bf16 v43, v158, v14, v43
    v_dot2_f32_bf16 v43, v159, v15, v43
    s_waitcnt vmcnt(4)
    s_add_u32 s35, s69, 98304
    buffer_load_dwordx4 v[156:159], v1, s[40:43], s35 offen offset:3072 nt
    v_dot2_f32_bf16 v44, v160, v12, 0
    v_dot2_f32_bf16 v44, v161, v13, v44
    v_dot2_f32_bf16 v44, v162, v14, v44
    v_dot2_f32_bf16 v44, v163, v15, v44
    s_waitcnt vmcnt(4)
    s_add_u32 s35, s69, 102400
    buffer_load_dwordx4 v[160:163], v1, s[40:43], s35 offen offset:0 nt
    v_dot2_f32_bf16 v45, v164, v12, 0
    v_dot2_f32_bf16 v45, v165, v13, v45
    v_dot2_f32_bf16 v45, v166, v14, v45
    v_dot2_f32_bf16 v45, v167, v15, v45
    s_waitcnt vmcnt(4)
    s_add_u32 s35, s69, 102400
    buffer_load_dwordx4 v[164:167], v1, s[40:43], s35 offen offset:1024 nt
    v_dot2_f32_bf16 v46, v168, v12, 0
    v_dot2_f32_bf16 v46, v169, v13, v46
    v_dot2_f32_bf16 v46, v170, v14, v46
    v_dot2_f32_bf16 v46, v171, v15, v46
    s_waitcnt vmcnt(4)
    s_add_u32 s35, s69, 102400
    buffer_load_dwordx4 v[168:171], v1, s[40:43], s35 offen offset:2048 nt
    v_dot2_f32_bf16 v47, v172, v12, 0
    v_dot2_f32_bf16 v47, v173, v13, v47
    v_dot2_f32_bf16 v47, v174, v14, v47
    v_dot2_f32_bf16 v47, v175, v15, v47
    s_waitcnt vmcnt(4)
    s_add_u32 s35, s69, 102400
    buffer_load_dwordx4 v[172:175], v1, s[40:43], s35 offen offset:3072 nt
    v_add_f32_dpp v32, v32, v32 row_ror:8 row_mask:0xf bank_mask:0x3
    v_add_f32_dpp v32, v40, v40 row_ror:8 row_mask:0xf bank_mask:0xc
    v_add_f32_dpp v33, v33, v33 row_ror:8 row_mask:0xf bank_mask:0x3
    v_add_f32_dpp v33, v41, v41 row_ror:8 row_mask:0xf bank_mask:0xc
    v_add_f32_dpp v34, v34, v34 row_ror:8 row_mask:0xf bank_mask:0x3
    v_add_f32_dpp v34, v42, v42 row_ror:8 row_mask:0xf bank_mask:0xc
    v_add_f32_dpp v35, v35, v35 row_ror:8 row_mask:0xf bank_mask:0x3
    v_add_f32_dpp v35, v43, v43 row_ror:8 row_mask:0xf bank_mask:0xc
    v_add_f32_dpp v36, v36, v36 row_ror:8 row_mask:0xf bank_mask:0x3
    v_add_f32_dpp v36, v44, v44 row_ror:8 row_mask:0xf bank_mask:0xc
    v_add_f32_dpp v37, v37, v37 row_ror:8 row_mask:0xf bank_mask:0x3
    v_add_f32_dpp v37, v45, v45 row_ror:8 row_mask:0xf bank_mask:0xc
    v_add_f32_dpp v38, v38, v38 row_ror:8 row_mask:0xf bank_mask:0x3
    v_add_f32_dpp v38, v46, v46 row_ror:8 row_mask:0xf bank_mask:0xc
    v_add_f32_dpp v39, v39, v39 row_ror:8 row_mask:0xf bank_mask:0x3
    v_add_f32_dpp v39, v47, v47 row_ror:8 row_mask:0xf bank_mask:0xc
    v_add_f32_dpp v32, v32, v32 row_shl:4 row_mask:0xf bank_mask:0x5
    v_add_f32_dpp v32, v36, v36 row_shr:4 row_mask:0xf bank_mask:0xa
    v_add_f32_dpp v33, v33, v33 row_shl:4 row_mask:0xf bank_mask:0x5
    v_add_f32_dpp v33, v37, v37 row_shr:4 row_mask:0xf bank_mask:0xa
    v_add_f32_dpp v34, v34, v34 row_shl:4 row_mask:0xf bank_mask:0x5
    v_add_f32_dpp v34, v38, v38 row_shr:4 row_mask:0xf bank_mask:0xa
    v_add_f32_dpp v35, v35, v35 row_shl:4 row_mask:0xf bank_mask:0x5
    v_add_f32_dpp v35, v39, v39 row_shr:4 row_mask:0xf bank_mask:0xa
    v_cndmask_b32 v5, v32, v34, s[62:63]
    v_cndmask_b32 v6, v34, v32, s[62:63]
    v_cndmask_b32 v7, v33, v35, s[62:63]
    v_cndmask_b32 v29, v35, v33, s[62:63]
    v_add_f32_dpp v5, v6, v5 quad_perm:[2,3,0,1] row_mask:0xf bank_mask:0xf
    s_nop 0
    v_add_f32_dpp v7, v29, v7 quad_perm:[2,3,0,1] row_mask:0xf bank_mask:0xf
    v_cndmask_b32 v28, v5, v7, s[64:65]
    v_cndmask_b32 v6, v7, v5, s[64:65]
    s_nop 1
    v_add_f32_dpp v28, v6, v28 quad_perm:[1,0,3,2] row_mask:0xf bank_mask:0xf
    v_cvt_pk_bf16_f32 v28, v28, v28
    v_lshlrev_b32 v28, 16, v28
    v_mul_f32 v28, s71, v28
    v_cvt_pk_bf16_f32 v28, v28, v28
    v_lshlrev_b32 v28, 16, v28
    ds_write_b32 v182, v28 offset:256
    v_max_f32 v5, v2, v28
    v_sub_f32 v6, v2, v5
    v_sub_f32 v7, v28, v5
    v_mul_f32 v6, s68, v6
    v_mul_f32 v7, s68, v7
    v_exp_f32 v6, v6
    v_exp_f32 v7, v7
    v_mov_b32 v2, v5
    v_fma_f32 v3, v3, v6, v7
    v_add_u32 v182, 512, v182
    s_add_u32 s69, s69, 131072
    s_sub_u32 s59, s59, 1
    s_cmp_lg_u32 s59, 0
    s_cbranch_scc1 L_kloop0
    s_mov_b32 s69, s34
    v_dot2_f32_bf16 v32, v48, v12, 0
    v_dot2_f32_bf16 v32, v49, v13, v32
    v_dot2_f32_bf16 v32, v50, v14, v32
    v_dot2_f32_bf16 v32, v51, v15, v32
    v_dot2_f32_bf16 v33, v52, v12, 0
    v_dot2_f32_bf16 v33, v53, v13, v33
    v_dot2_f32_bf16 v33, v54, v14, v33
    v_dot2_f32_bf16 v33, v55, v15, v33
    v_dot2_f32_bf16 v34, v56, v12, 0
    v_dot2_f32_bf16 v34, v57, v13, v34
    v_dot2_f32_bf16 v34, v58, v14, v34
    v_dot2_f32_bf16 v34, v59, v15, v34
    v_dot2_f32_bf16 v35, v60, v12, 0
    v_dot2_f32_bf16 v35, v61, v13, v35
    v_dot2_f32_bf16 v35, v62, v14, v35
    v_dot2_f32_bf16 v35, v63, v15, v35
    s_waitcnt vmcnt(4)
    buffer_load_dwordx4 v[48:51], v1, s[44:47], s69 offen offset:0 nt
    v_dot2_f32_bf16 v36, v64, v12, 0
    v_dot2_f32_bf16 v36, v65, v13, v36
    v_dot2_f32_bf16 v36, v66, v14, v36
    v_dot2_f32_bf16 v36, v67, v15, v36
    v_dot2_f32_bf16 v37, v68, v12, 0
    v_dot2_f32_bf16 v37, v69, v13, v37
    v_dot2_f32_bf16 v37, v70, v14, v37
    v_dot2_f32_bf16 v37, v71, v15, v37
    v_dot2_f32_bf16 v38, v72, v12, 0
    v_dot2_f32_bf16 v38, v73, v13, v38
    v_dot2_f32_bf16 v38, v74, v14, v38
    v_dot2_f32_bf16 v38, v75, v15, v38
    v_dot2_f32_bf16 v39, v76, v12, 0
    v_dot2_f32_bf16 v39, v77, v13, v39
    v_dot2_f32_bf16 v39, v78, v14, v39
    v_dot2_f32_bf16 v39, v79, v15, v39
    s_waitcnt vmcnt(4)
    buffer_load_dwordx4 v[52:55], v1, s[44:47], s69 offen offset:1024 nt
    v_dot2_f32_bf16 v40, v80, v12, 0
    v_dot2_f32_bf16 v40, v81, v13, v40
    v_dot2_f32_bf16 v40, v82, v14, v40
    v_dot2_f32_bf16 v40, v83, v15, v40
    v_dot2_f32_bf16 v41, v84, v12, 0
    v_dot2_f32_bf16 v41, v85, v13, v41
    v_dot2_f32_bf16 v41, v86, v14, v41
    v_dot2_f32_bf16 v41, v87, v15, v41
    v_dot2_f32_bf16 v42, v88, v12, 0
    v_dot2_f32_bf16 v42, v89, v13, v42
    v_dot2_f32_bf16 v42, v90, v14, v42
    v_dot2_f32_bf16 v42, v91, v15, v42
    v_dot2_f32_bf16 v43, v92, v12, 0
    v_dot2_f32_bf16 v43, v93, v13, v43
    v_dot2_f32_bf16 v43, v94, v14, v43
    v_dot2_f32_bf16 v43, v95, v15, v43
    s_waitcnt vmcnt(4)
    buffer_load_dwordx4 v[56:59], v1, s[44:47], s69 offen offset:2048 nt
    v_dot2_f32_bf16 v44, v96, v12, 0
    v_dot2_f32_bf16 v44, v97, v13, v44
    v_dot2_f32_bf16 v44, v98, v14, v44
    v_dot2_f32_bf16 v44, v99, v15, v44
    v_dot2_f32_bf16 v45, v100, v12, 0
    v_dot2_f32_bf16 v45, v101, v13, v45
    v_dot2_f32_bf16 v45, v102, v14, v45
    v_dot2_f32_bf16 v45, v103, v15, v45
    v_dot2_f32_bf16 v46, v104, v12, 0
    v_dot2_f32_bf16 v46, v105, v13, v46
    v_dot2_f32_bf16 v46, v106, v14, v46
    v_dot2_f32_bf16 v46, v107, v15, v46
    v_dot2_f32_bf16 v47, v108, v12, 0
    v_dot2_f32_bf16 v47, v109, v13, v47
    v_dot2_f32_bf16 v47, v110, v14, v47
    v_dot2_f32_bf16 v47, v111, v15, v47
    v_add_f32_dpp v32, v32, v32 row_ror:8 row_mask:0xf bank_mask:0x3
    v_add_f32_dpp v32, v40, v40 row_ror:8 row_mask:0xf bank_mask:0xc
    v_add_f32_dpp v33, v33, v33 row_ror:8 row_mask:0xf bank_mask:0x3
    v_add_f32_dpp v33, v41, v41 row_ror:8 row_mask:0xf bank_mask:0xc
    v_add_f32_dpp v34, v34, v34 row_ror:8 row_mask:0xf bank_mask:0x3
    v_add_f32_dpp v34, v42, v42 row_ror:8 row_mask:0xf bank_mask:0xc
    v_add_f32_dpp v35, v35, v35 row_ror:8 row_mask:0xf bank_mask:0x3
    v_add_f32_dpp v35, v43, v43 row_ror:8 row_mask:0xf bank_mask:0xc
    v_add_f32_dpp v36, v36, v36 row_ror:8 row_mask:0xf bank_mask:0x3
    v_add_f32_dpp v36, v44, v44 row_ror:8 row_mask:0xf bank_mask:0xc
    v_add_f32_dpp v37, v37, v37 row_ror:8 row_mask:0xf bank_mask:0x3
    v_add_f32_dpp v37, v45, v45 row_ror:8 row_mask:0xf bank_mask:0xc
    v_add_f32_dpp v38, v38, v38 row_ror:8 row_mask:0xf bank_mask:0x3
    v_add_f32_dpp v38, v46, v46 row_ror:8 row_mask:0xf bank_mask:0xc
    v_add_f32_dpp v39, v39, v39 row_ror:8 row_mask:0xf bank_mask:0x3
    v_add_f32_dpp v39, v47, v47 row_ror:8 row_mask:0xf bank_mask:0xc
    v_add_f32_dpp v32, v32, v32 row_shl:4 row_mask:0xf bank_mask:0x5
    v_add_f32_dpp v32, v36, v36 row_shr:4 row_mask:0xf bank_mask:0xa
    v_add_f32_dpp v33, v33, v33 row_shl:4 row_mask:0xf bank_mask:0x5
    v_add_f32_dpp v33, v37, v37 row_shr:4 row_mask:0xf bank_mask:0xa
    v_add_f32_dpp v34, v34, v34 row_shl:4 row_mask:0xf bank_mask:0x5
    v_add_f32_dpp v34, v38, v38 row_shr:4 row_mask:0xf bank_mask:0xa
    v_add_f32_dpp v35, v35, v35 row_shl:4 row_mask:0xf bank_mask:0x5
    v_add_f32_dpp v35, v39, v39 row_shr:4 row_mask:0xf bank_mask:0xa
    v_cndmask_b32 v5, v32, v34, s[62:63]
    v_cndmask_b32 v6, v34, v32, s[62:63]
    v_cndmask_b32 v7, v33, v35, s[62:63]
    v_cndmask_b32 v29, v35, v33, s[62:63]
    v_add_f32_dpp v5, v6, v5 quad_perm:[2,3,0,1] row_mask:0xf bank_mask:0xf
    s_nop 0
    v_add_f32_dpp v7, v29, v7 quad_perm:[2,3,0,1] row_mask:0xf bank_mask:0xf
    v_cndmask_b32 v28, v5, v7, s[64:65]
    v_cndmask_b32 v6, v7, v5, s[64:65]
    s_nop 1
    v_add_f32_dpp v28, v6, v28 quad_perm:[1,0,3,2] row_mask:0xf bank_mask:0xf
    v_cvt_pk_bf16_f32 v28, v28, v28
    v_lshlrev_b32 v28, 16, v28
    v_mul_f32 v28, s71, v28
    v_cvt_pk_bf16_f32 v28, v28, v28
    v_lshlrev_b32 v28, 16, v28
    ds_write_b32 v182, v28 offset:0
    v_max_f32 v5, v2, v28
    v_sub_f32 v6, v2, v5
    v_sub_f32 v7, v28, v5
    v_mul_f32 v6, s68, v6
    v_mul_f32 v7, s68, v7
    v_exp_f32 v6, v6
    v_exp_f32 v7, v7
    v_mov_b32 v2, v5
    v_fma_f32 v3, v3, v6, v7
    s_waitcnt vmcnt(4)
    buffer_load_dwordx4 v[60:63], v1, s[44:47], s69 offen offset:3072 nt
    v_dot2_f32_bf16 v32, v112, v12, 0
    v_dot2_f32_bf16 v32, v113, v13, v32
    v_dot2_f32_bf16 v32, v114, v14, v32
    v_dot2_f32_bf16 v32, v115, v15, v32
    v_dot2_f32_bf16 v33, v116, v12, 0
    v_dot2_f32_bf16 v33, v117, v13, v33
    v_dot2_f32_bf16 v33, v118, v14, v33
    v_dot2_f32_bf16 v33, v119, v15, v33
    v_dot2_f32_bf16 v34, v120, v12, 0
    v_dot2_f32_bf16 v34, v121, v13, v34
    v_dot2_f32_bf16 v34, v122, v14, v34
    v_dot2_f32_bf16 v34, v123, v15, v34
    v_dot2_f32_bf16 v35, v124, v12, 0
    v_dot2_f32_bf16 v35, v125, v13, v35
    v_dot2_f32_bf16 v35, v126, v14, v35
    v_dot2_f32_bf16 v35, v127, v15, v35
    s_waitcnt vmcnt(4)
    s_add_u32 s35, s69, 4096
    buffer_load_dwordx4 v[64:67], v1, s[44:47], s35 offen offset:0 nt
    v_dot2_f32_bf16 v36, v128, v12, 0
    v_dot2_f32_bf16 v36, v129, v13, v36
    v_dot2_f32_bf16 v36, v130, v14, v36
    v_dot2_f32_bf16 v36, v131, v15, v36
    v_dot2_f32_bf16 v37, v132, v12, 0
    v_dot2_f32_bf16 v37, v133, v13, v37
    v_dot2_f32_bf16 v37, v134, v14, v37
    v_dot2_f32_bf16 v37, v135, v15, v37
    v_dot2_f32_bf16 v38, v136, v12, 0
    v_dot2_f32_bf16 v38, v137, v13, v38
    v_dot2_f32_bf16 v38, v138, v14, v38
    v_dot2_f32_bf16 v38, v139, v15, v38
    v_dot2_f32_bf16 v39, v140, v12, 0
    v_dot2_f32_bf16 v39, v141, v13, v39
    v_dot2_f32_bf16 v39, v142, v14, v39
    v_dot2_f32_bf16 v39, v143, v15, v39
    s_waitcnt vmcnt(4)
    s_add_u32 s35, s69, 4096
    buffer_load_dwordx4 v[68:71], v1, s[44:47], s35 offen offset:1024 nt
    v_dot2_f32_bf16 v40, v144, v12, 0
    v_dot2_f32_bf16 v40, v145, v13, v40
    v_dot2_f32_bf16 v40, v146, v14, v40
    v_dot2_f32_bf16 v40, v147, v15, v40
    v_dot2_f32_bf16 v41, v148, v12, 0
    v_dot2_f32_bf16 v41, v149, v13, v41
    v_dot2_f32_bf16 v41, v150, v14, v41
    v_dot2_f32_bf16 v41, v151, v15, v41
    v_dot2_f32_bf16 v42, v152, v12, 0
    v_dot2_f32_bf16 v42, v153, v13, v42
    v_dot2_f32_bf16 v42, v154, v14, v42
    v_dot2_f32_bf16 v42, v155, v15, v42
    s_waitcnt vmcnt(10)
    v_dot2_f32_bf16 v43, v156, v12, 0
    v_dot2_f32_bf16 v43, v157, v13, v43
    v_dot2_f32_bf16 v43, v158, v14, v43
    v_dot2_f32_bf16 v43, v159, v15, v43
    s_waitcnt vmcnt(4)
    s_add_u32 s35, s69, 4096
    buffer_load_dwordx4 v[72:75], v1, s[44:47], s35 offen offset:2048 nt
    s_waitcnt vmcnt(10)
    v_dot2_f32_bf16 v44, v160, v12, 0
    v_dot2_f32_bf16 v44, v161, v13, v44
    v_dot2_f32_bf16 v44, v162, v14, v44
    v_dot2_f32_bf16 v44, v163, v15, v44
    s_waitcnt vmcnt(9)
    v_dot2_f32_bf16 v45, v164, v12, 0
    v_dot2_f32_bf16 v45, v165, v13, v45
    v_dot2_f32_bf16 v45, v166, v14, v45
    v_dot2_f32_bf16 v45, v167, v15, v45
    s_waitcnt vmcnt(8)
    v_dot2_f32_bf16 v46, v168, v12, 0
    v_dot2_f32_bf16 v46, v169, v13, v46
    v_dot2_f32_bf16 v46, v170, v14, v46
    v_dot2_f32_bf16 v46, v171, v15, v46
    s_waitcnt vmcnt(7)
    v_dot2_f32_bf16 v47, v172, v12, 0
    v_dot2_f32_bf16 v47, v173, v13, v47
    v_dot2_f32_bf16 v47, v174, v14, v47
    v_dot2_f32_bf16 v47, v175, v15, v47
    v_add_f32_dpp v32, v32, v32 row_ror:8 row_mask:0xf bank_mask:0x3
    v_add_f32_dpp v32, v40, v40 row_ror:8 row_mask:0xf bank_mask:0xc
    v_add_f32_dpp v33, v33, v33 row_ror:8 row_mask:0xf bank_mask:0x3
    v_add_f32_dpp v33, v41, v41 row_ror:8 row_mask:0xf bank_mask:0xc
    v_add_f32_dpp v34, v34, v34 row_ror:8 row_mask:0xf bank_mask:0x3
    v_add_f32_dpp v34, v42, v42 row_ror:8 row_mask:0xf bank_mask:0xc
    v_add_f32_dpp v35, v35, v35 row_ror:8 row_mask:0xf bank_mask:0x3
    v_add_f32_dpp v35, v43, v43 row_ror:8 row_mask:0xf bank_mask:0xc
    v_add_f32_dpp v36, v36, v36 row_ror:8 row_mask:0xf bank_mask:0x3
    v_add_f32_dpp v36, v44, v44 row_ror:8 row_mask:0xf bank_mask:0xc
    v_add_f32_dpp v37, v37, v37 row_ror:8 row_mask:0xf bank_mask:0x3
    v_add_f32_dpp v37, v45, v45 row_ror:8 row_mask:0xf bank_mask:0xc
    v_add_f32_dpp v38, v38, v38 row_ror:8 row_mask:0xf bank_mask:0x3
    v_add_f32_dpp v38, v46, v46 row_ror:8 row_mask:0xf bank_mask:0xc
    v_add_f32_dpp v39, v39, v39 row_ror:8 row_mask:0xf bank_mask:0x3
    v_add_f32_dpp v39, v47, v47 row_ror:8 row_mask:0xf bank_mask:0xc
    v_add_f32_dpp v32, v32, v32 row_shl:4 row_mask:0xf bank_mask:0x5
    v_add_f32_dpp v32, v36, v36 row_shr:4 row_mask:0xf bank_mask:0xa
    v_add_f32_dpp v33, v33, v33 row_shl:4 row_mask:0xf bank_mask:0x5
    v_add_f32_dpp v33, v37, v37 row_shr:4 row_mask:0xf bank_mask:0xa
    v_add_f32_dpp v34, v34, v34 row_shl:4 row_mask:0xf bank_mask:0x5
    v_add_f32_dpp v34, v38, v38 row_shr:4 row_mask:0xf bank_mask:0xa
    v_add_f32_dpp v35, v35, v35 row_shl:4 row_mask:0xf bank_mask:0x5
    v_add_f32_dpp v35, v39, v39 row_shr:4 row_mask:0xf bank_mask:0xa
    v_cndmask_b32 v5, v32, v34, s[62:63]
    v_cndmask_b32 v6, v34, v32, s[62:63]
    v_cndmask_b32 v7, v33, v35, s[62:63]
    v_cndmask_b32 v29, v35, v33, s[62:63]
    v_add_f32_dpp v5, v6, v5 quad_perm:[2,3,0,1] row_mask:0xf bank_mask:0xf
    s_nop 0
    v_add_f32_dpp v7, v29, v7 quad_perm:[2,3,0,1] row_mask:0xf bank_mask:0xf
    v_cndmask_b32 v28, v5, v7, s[64:65]
    v_cndmask_b32 v6, v7, v5, s[64:65]
    s_nop 1
    v_add_f32_dpp v28, v6, v28 quad_perm:[1,0,3,2] row_mask:0xf bank_mask:0xf
    v_cvt_pk_bf16_f32 v28, v28, v28
    v_lshlrev_b32 v28, 16, v28
    v_mul_f32 v28, s71, v28
    v_cvt_pk_bf16_f32 v28, v28, v28
    v_lshlrev_b32 v28, 16, v28
    ds_write_b32 v182, v28 offset:256
    v_max_f32 v5, v2, v28
    v_sub_f32 v6, v2, v5
    v_sub_f32 v7, v28, v5
    v_mul_f32 v6, s68, v6
    v_mul_f32 v7, s68, v7
    v_exp_f32 v6, v6
    v_exp_f32 v7, v7
    v_mov_b32 v2, v5
    v_fma_f32 v3, v3, v6, v7
    v_add_u32 v182, 512, v182
    s_waitcnt vmcnt(4)
    s_add_u32 s35, s69, 4096
    buffer_load_dwordx4 v[76:79], v1, s[44:47], s35 offen offset:3072 nt
    v_mov_b32 v5, v2
    s_nop 1
    v_max_f32_dpp v5, v5, v5 row_ror:8 row_mask:0xf bank_mask:0xf
    s_nop 1
    v_max_f32_dpp v5, v5, v5 row_ror:4 row_mask:0xf bank_mask:0xf
    s_nop 1
    v_max_f32_dpp v5, v5, v5 row_ror:2 row_mask:0xf bank_mask:0xf
    s_nop 1
    v_max_f32_dpp v5, v5, v5 row_ror:1 row_mask:0xf bank_mask:0xf
    v_mov_b32 v6, v5
    s_nop 1
    v_permlane16_swap_b32 v5, v6
    v_max_f32 v5, v5, v6
    v_mov_b32 v6, v5
    s_nop 1
    v_permlane32_swap_b32 v5, v6
    v_max_f32 v5, v5, v6
    v_sub_f32 v6, v2, v5
    v_mul_f32 v6, s68, v6
    v_exp_f32 v6, v6
    s_nop 0
    v_mul_f32 v3, v3, v6
    v_mov_b32 v2, v5
    s_nop 0
    v_add_f32_dpp v3, v3, v3 row_ror:8 row_mask:0xf bank_mask:0xf
    s_nop 1
    v_add_f32_dpp v3, v3, v3 row_ror:4 row_mask:0xf bank_mask:0xf
    s_nop 1
    v_add_f32_dpp v3, v3, v3 row_ror:2 row_mask:0xf bank_mask:0xf
    s_nop 1
    v_add_f32_dpp v3, v3, v3 row_ror:1 row_mask:0xf bank_mask:0xf
    v_mov_b32 v6, v3
    s_nop 1
    v_permlane16_swap_b32 v3, v6
    v_add_f32 v3, v3, v6
    v_mov_b32 v6, v3
    s_nop 1
    v_permlane32_swap_b32 v3, v6
    v_add_f32 v3, v3, v6
    v_mov_b32 v5, s3
    v_lshlrev_b32 v5, 3, v5
    v_add_u32 v5, 98816, v5
    ds_write_b64 v5, v[2:3]
    v_mov_b32 v5, 98580
    v_mov_b32 v6, 1
    s_waitcnt lgkmcnt(0)
    s_mov_b64 exec, 1
    ds_add_u32 v5, v6
    s_mov_b64 exec, -1
    s_waitcnt vmcnt(4)
    s_add_u32 s35, s69, 32768
    buffer_load_dwordx4 v[80:83], v1, s[44:47], s35 offen offset:0 nt
    s_waitcnt vmcnt(4)
    s_add_u32 s35, s69, 32768
    buffer_load_dwordx4 v[84:87], v1, s[44:47], s35 offen offset:1024 nt
    s_waitcnt vmcnt(4)
    s_add_u32 s35, s69, 32768
    buffer_load_dwordx4 v[88:91], v1, s[44:47], s35 offen offset:2048 nt
    s_waitcnt vmcnt(4)
    s_add_u32 s35, s69, 32768
    buffer_load_dwordx4 v[92:95], v1, s[44:47], s35 offen offset:3072 nt
    s_waitcnt vmcnt(4)
    s_add_u32 s35, s69, 36864
    buffer_load_dwordx4 v[96:99], v1, s[44:47], s35 offen offset:0 nt
    s_waitcnt vmcnt(4)
    s_add_u32 s35, s69, 36864
    buffer_load_dwordx4 v[100:103], v1, s[44:47], s35 offen offset:1024 nt
    s_waitcnt vmcnt(4)
    s_add_u32 s35, s69, 36864
    buffer_load_dwordx4 v[104:107], v1, s[44:47], s35 offen offset:2048 nt
    s_waitcnt vmcnt(4)
    s_add_u32 s35, s69, 36864
    buffer_load_dwordx4 v[108:111], v1, s[44:47], s35 offen offset:3072 nt
    s_waitcnt vmcnt(4)
    s_add_u32 s35, s69, 65536
    buffer_load_dwordx4 v[112:115], v1, s[44:47], s35 offen offset:0 nt
    s_waitcnt vmcnt(4)
    s_add_u32 s35, s69, 65536
    buffer_load_dwordx4 v[116:119], v1, s[44:47], s35 offen offset:1024 nt
    s_waitcnt vmcnt(4)
    s_add_u32 s35, s69, 65536
    buffer_load_dwordx4 v[120:123], v1, s[44:47], s35 offen offset:2048 nt
    s_waitcnt vmcnt(4)
    s_add_u32 s35, s69, 65536
    buffer_load_dwordx4 v[124:127], v1, s[44:47], s35 offen offset:3072 nt
    s_waitcnt vmcnt(4)
    s_add_u32 s35, s69, 69632
    buffer_load_dwordx4 v[128:131], v1, s[44:47], s35 offen offset:0 nt
    s_waitcnt vmcnt(4)
    s_add_u32 s35, s69, 69632
    buffer_load_dwordx4 v[132:135], v1, s[44:47], s35 offen offset:1024 nt
    s_waitcnt vmcnt(4)
    s_add_u32 s35, s69, 69632
    buffer_load_dwordx4 v[136:139], v1, s[44:47], s35 offen offset:2048 nt
    s_waitcnt vmcnt(4)
    s_add_u32 s35, s69, 69632
    buffer_load_dwordx4 v[140:143], v1, s[44:47], s35 offen offset:3072 nt
    s_waitcnt vmcnt(4)
    s_add_u32 s35, s69, 98304
    buffer_load_dwordx4 v[144:147], v1, s[44:47], s35 offen offset:0 nt
    s_waitcnt vmcnt(4)
    s_add_u32 s35, s69, 98304
    buffer_load_dwordx4 v[148:151], v1, s[44:47], s35 offen offset:1024 nt
    s_waitcnt vmcnt(4)
    s_add_u32 s35, s69, 98304
    buffer_load_dwordx4 v[152:155], v1, s[44:47], s35 offen offset:2048 nt
    s_waitcnt vmcnt(4)
    s_add_u32 s35, s69, 98304
    buffer_load_dwordx4 v[156:159], v1, s[44:47], s35 offen offset:3072 nt
    s_waitcnt vmcnt(4)
    s_add_u32 s35, s69, 102400
    buffer_load_dwordx4 v[160:163], v1, s[44:47], s35 offen offset:0 nt
    s_waitcnt vmcnt(4)
    s_add_u32 s35, s69, 102400
    buffer_load_dwordx4 v[164:167], v1, s[44:47], s35 offen offset:1024 nt
    s_waitcnt vmcnt(4)
    s_add_u32 s35, s69, 102400
    buffer_load_dwordx4 v[168:171], v1, s[44:47], s35 offen offset:2048 nt
    s_waitcnt vmcnt(4)
    s_add_u32 s35, s69, 102400
    buffer_load_dwordx4 v[172:175], v1, s[44:47], s35 offen offset:3072 nt
    s_add_u32 s69, s69, 131072
    v_mov_b32 v5, 98580
    s_mov_b32 s58, 3200000
L_scw:
    ds_read_b32 v6, v5
    s_waitcnt lgkmcnt(0)
    v_readfirstlane_b32 s57, v6
    s_nop 0
    s_cmp_ge_u32 s57, 4
    s_cbranch_scc1 L_sck
    s_sub_u32 s58, s58, 1
    s_cmp_eq_u32 s58, 0
    s_cbranch_scc1 L_sck
    s_branch L_scw
L_sck:
    v_mov_b32 v5, 98816
    ds_read_b128 v[32:35], v5
    ds_read_b128 v[36:39], v5 offset:16
    v_lshl_add_u32 v182, v0, 2, s70
    ds_read_b32 v28, v182
    ds_read_b32 v183, v182 offset:256
    s_waitcnt lgkmcnt(2)
    v_max3_f32 v2, v32, v34, v36
    v_max_f32 v2, v2, v38
    v_sub_f32 v32, v32, v2
    v_sub_f32 v34, v34, v2
    v_sub_f32 v36, v36, v2
    v_sub_f32 v38, v38, v2
    v_mul_f32 v32, s68, v32
    v_mul_f32 v34, s68, v34
    v_mul_f32 v36, s68, v36
    v_mul_f32 v38, s68, v38
    v_exp_f32 v32, v32
    v_exp_f32 v34, v34
    v_exp_f32 v36, v36
    v_exp_f32 v38, v38
    v_mul_f32 v3, v32, v33
    v_fmac_f32 v3, v34, v35
    v_fmac_f32 v3, v36, v37
    v_fmac_f32 v3, v38, v39
    v_rcp_f32 v5, v3
    s_nop 0
    v_fma_f32 v6, -v3, v5, 1.0
    v_fma_f32 v3, v6, v5, v5
    s_mov_b32 s13, 5
    s_mov_b32 s14, 98576
L_stage:
    v_mov_b32 v5, s14
    ds_read_b32 v6, v5
    s_waitcnt lgkmcnt(0)
    v_readfirstlane_b32 s8, v6
    s_nop 0
    s_and_b32 s9, s8, 0xff
    s_bfe_u32 s10, s8, 0x80008
    s_lshr_b32 s12, s8, 16
    s_sub_u32 s11, s13, s9
    s_sub_u32 s11, s11, s10
    s_sub_u32 s11, s11, s12
    s_cmp_eq_u32 s12, 0
    s_cbranch_scc1 L_vskiphi2
L_vloophi2:
    s_nop 1
    s_sub_u32 s13, s13, 1
    s_cmp_lg_u32 s13, 0
    s_cbranch_scc1 L_nphi2
    v_mov_b32 v5, 98588
    v_mov_b32 v6, 1
    ds_write_b32 v5, v6
L_nphi2:
    s_waitcnt lgkmcnt(0)
    v_sub_f32 v28, v28, v2
    v_mul_f32 v28, s68, v28
    v_exp_f32 v28, v28
    s_nop 0
    v_mul_f32 v28, v28, v3
    v_cvt_pk_bf16_f32 v4, v28, v28
    v_sub_f32 v183, v183, v2
    v_mul_f32 v183, s68, v183
    v_exp_f32 v183, v183
    s_nop 0
    v_mul_f32 v183, v183, v3
    v_cvt_pk_bf16_f32 v30, v183, v183
    v_add_u32 v182, 512, v182
    ds_read_b32 v28, v182
    ds_read_b32 v183, v182 offset:256
    v_and_b32_dpp v20, v4, v16 row_newbcast:0 row_mask:0xf bank_mask:0xf
    v_and_b32_dpp v21, v4, v17 row_newbcast:0 row_mask:0xf bank_mask:0xf
    v_and_b32_dpp v22, v4, v18 row_newbcast:0 row_mask:0xf bank_mask:0xf
    v_and_b32_dpp v23, v4, v19 row_newbcast:0 row_mask:0xf bank_mask:0xf
    s_nop 1
    v_mfma_f32_16x16x32_bf16 v[8:11], v[20:23], v[48:51], v[8:11]
    s_waitcnt vmcnt(7)
    buffer_load_dwordx4 v[48:51], v1, s[44:47], s69 offen offset:0 nt
    v_and_b32_dpp v24, v4, v16 row_newbcast:1 row_mask:0xf bank_mask:0xf
    v_and_b32_dpp v25, v4, v17 row_newbcast:1 row_mask:0xf bank_mask:0xf
    v_and_b32_dpp v26, v4, v18 row_newbcast:1 row_mask:0xf bank_mask:0xf
    v_and_b32_dpp v27, v4, v19 row_newbcast:1 row_mask:0xf bank_mask:0xf
    s_nop 1
    v_mfma_f32_16x16x32_bf16 v[8:11], v[24:27], v[52:55], v[8:11]
    s_waitcnt vmcnt(7)
    buffer_load_dwordx4 v[52:55], v1, s[44:47], s69 offen offset:1024 nt
    v_and_b32_dpp v20, v4, v16 row_newbcast:2 row_mask:0xf bank_mask:0xf
    v_and_b32_dpp v21, v4, v17 row_newbcast:2 row_mask:0xf bank_mask:0xf
    v_and_b32_dpp v22, v4, v18 row_newbcast:2 row_mask:0xf bank_mask:0xf
    v_and_b32_dpp v23, v4, v19 row_newbcast:2 row_mask:0xf bank_mask:0xf
    s_nop 1
    v_mfma_f32_16x16x32_bf16 v[8:11], v[20:23], v[56:59], v[8:11]
    s_waitcnt vmcnt(7)
    buffer_load_dwordx4 v[56:59], v1, s[44:47], s69 offen offset:2048 nt
    v_and_b32_dpp v24, v4, v16 row_newbcast:3 row_mask:0xf bank_mask:0xf
    v_and_b32_dpp v25, v4, v17 row_newbcast:3 row_mask:0xf bank_mask:0xf
    v_and_b32_dpp v26, v4, v18 row_newbcast:3 row_mask:0xf bank_mask:0xf
    v_and_b32_dpp v27, v4, v19 row_newbcast:3 row_mask:0xf bank_mask:0xf
    s_nop 1
    v_mfma_f32_16x16x32_bf16 v[8:11], v[24:27], v[60:63], v[8:11]
    s_waitcnt vmcnt(7)
    buffer_load_dwordx4 v[60:63], v1, s[44:47], s69 offen offset:3072 nt
    v_and_b32_dpp v20, v4, v16 row_newbcast:4 row_mask:0xf bank_mask:0xf
    v_and_b32_dpp v21, v4, v17 row_newbcast:4 row_mask:0xf bank_mask:0xf
    v_and_b32_dpp v22, v4, v18 row_newbcast:4 row_mask:0xf bank_mask:0xf
    v_and_b32_dpp v23, v4, v19 row_newbcast:4 row_mask:0xf bank_mask:0xf
    s_nop 1
    v_mfma_f32_16x16x32_bf16 v[8:11], v[20:23], v[64:67], v[8:11]
    s_waitcnt vmcnt(7)
    s_add_u32 s35, s69, 4096
    buffer_load_dwordx4 v[64:67], v1, s[44:47], s35 offen offset:0 nt
    v_and_b32_dpp v24, v4, v16 row_newbcast:5 row_mask:0xf bank_mask:0xf
    v_and_b32_dpp v25, v4, v17 row_newbcast:5 row_mask:0xf bank_mask:0xf
    v_and_b32_dpp v26, v4, v18 row_newbcast:5 row_mask:0xf bank_mask:0xf
    v_and_b32_dpp v27, v4, v19 row_newbcast:5 row_mask:0xf bank_mask:0xf
    s_nop 1
    v_mfma_f32_16x16x32_bf16 v[8:11], v[24:27], v[68:71], v[8:11]
    s_waitcnt vmcnt(7)
    s_add_u32 s35, s69, 4096
    buffer_load_dwordx4 v[68:71], v1, s[44:47], s35 offen offset:1024 nt
    v_and_b32_dpp v20, v4, v16 row_newbcast:6 row_mask:0xf bank_mask:0xf
    v_and_b32_dpp v21, v4, v17 row_newbcast:6 row_mask:0xf bank_mask:0xf
    v_and_b32_dpp v22, v4, v18 row_newbcast:6 row_mask:0xf bank_mask:0xf
    v_and_b32_dpp v23, v4, v19 row_newbcast:6 row_mask:0xf bank_mask:0xf
    s_nop 1
    v_mfma_f32_16x16x32_bf16 v[8:11], v[20:23], v[72:75], v[8:11]
    s_waitcnt vmcnt(7)
    s_add_u32 s35, s69, 4096
    buffer_load_dwordx4 v[72:75], v1, s[44:47], s35 offen offset:2048 nt
    v_and_b32_dpp v24, v4, v16 row_newbcast:7 row_mask:0xf bank_mask:0xf
    v_and_b32_dpp v25, v4, v17 row_newbcast:7 row_mask:0xf bank_mask:0xf
    v_and_b32_dpp v26, v4, v18 row_newbcast:7 row_mask:0xf bank_mask:0xf
    v_and_b32_dpp v27, v4, v19 row_newbcast:7 row_mask:0xf bank_mask:0xf
    s_nop 1
    v_mfma_f32_16x16x32_bf16 v[8:11], v[24:27], v[76:79], v[8:11]
    s_waitcnt vmcnt(7)
    s_add_u32 s35, s69, 4096
    buffer_load_dwordx4 v[76:79], v1, s[44:47], s35 offen offset:3072 nt
    v_and_b32_dpp v20, v4, v16 row_newbcast:8 row_mask:0xf bank_mask:0xf
    v_and_b32_dpp v21, v4, v17 row_newbcast:8 row_mask:0xf bank_mask:0xf
    v_and_b32_dpp v22, v4, v18 row_newbcast:8 row_mask:0xf bank_mask:0xf
    v_and_b32_dpp v23, v4, v19 row_newbcast:8 row_mask:0xf bank_mask:0xf
    s_nop 1
    v_mfma_f32_16x16x32_bf16 v[8:11], v[20:23], v[80:83], v[8:11]
    s_waitcnt vmcnt(7)
    s_add_u32 s35, s69, 32768
    buffer_load_dwordx4 v[80:83], v1, s[44:47], s35 offen offset:0 nt
    v_and_b32_dpp v24, v4, v16 row_newbcast:9 row_mask:0xf bank_mask:0xf
    v_and_b32_dpp v25, v4, v17 row_newbcast:9 row_mask:0xf bank_mask:0xf
    v_and_b32_dpp v26, v4, v18 row_newbcast:9 row_mask:0xf bank_mask:0xf
    v_and_b32_dpp v27, v4, v19 row_newbcast:9 row_mask:0xf bank_mask:0xf
    s_nop 1
    v_mfma_f32_16x16x32_bf16 v[8:11], v[24:27], v[84:87], v[8:11]
    s_waitcnt vmcnt(7)
    s_add_u32 s35, s69, 32768
    buffer_load_dwordx4 v[84:87], v1, s[44:47], s35 offen offset:1024 nt
    v_and_b32_dpp v20, v4, v16 row_newbcast:10 row_mask:0xf bank_mask:0xf
    v_and_b32_dpp v21, v4, v17 row_newbcast:10 row_mask:0xf bank_mask:0xf
    v_and_b32_dpp v22, v4, v18 row_newbcast:10 row_mask:0xf bank_mask:0xf
    v_and_b32_dpp v23, v4, v19 row_newbcast:10 row_mask:0xf bank_mask:0xf
    s_nop 1
    v_mfma_f32_16x16x32_bf16 v[8:11], v[20:23], v[88:91], v[8:11]
    s_waitcnt vmcnt(7)
    s_add_u32 s35, s69, 32768
    buffer_load_dwordx4 v[88:91], v1, s[44:47], s35 offen offset:2048 nt
    v_and_b32_dpp v24, v4, v16 row_newbcast:11 row_mask:0xf bank_mask:0xf
    v_and_b32_dpp v25, v4, v17 row_newbcast:11 row_mask:0xf bank_mask:0xf
    v_and_b32_dpp v26, v4, v18 row_newbcast:11 row_mask:0xf bank_mask:0xf
    v_and_b32_dpp v27, v4, v19 row_newbcast:11 row_mask:0xf bank_mask:0xf
    s_nop 1
    v_mfma_f32_16x16x32_bf16 v[8:11], v[24:27], v[92:95], v[8:11]
    s_waitcnt vmcnt(7)
    s_add_u32 s35, s69, 32768
    buffer_load_dwordx4 v[92:95], v1, s[44:47], s35 offen offset:3072 nt
    v_and_b32_dpp v20, v4, v16 row_newbcast:12 row_mask:0xf bank_mask:0xf
    v_and_b32_dpp v21, v4, v17 row_newbcast:12 row_mask:0xf bank_mask:0xf
    v_and_b32_dpp v22, v4, v18 row_newbcast:12 row_mask:0xf bank_mask:0xf
    v_and_b32_dpp v23, v4, v19 row_newbcast:12 row_mask:0xf bank_mask:0xf
    s_nop 1
    v_mfma_f32_16x16x32_bf16 v[8:11], v[20:23], v[96:99], v[8:11]
    s_waitcnt vmcnt(7)
    s_add_u32 s35, s69, 36864
    buffer_load_dwordx4 v[96:99], v1, s[44:47], s35 offen offset:0 nt
    v_and_b32_dpp v24, v4, v16 row_newbcast:13 row_mask:0xf bank_mask:0xf
    v_and_b32_dpp v25, v4, v17 row_newbcast:13 row_mask:0xf bank_mask:0xf
    v_and_b32_dpp v26, v4, v18 row_newbcast:13 row_mask:0xf bank_mask:0xf
    v_and_b32_dpp v27, v4, v19 row_newbcast:13 row_mask:0xf bank_mask:0xf
    s_nop 1
    v_mfma_f32_16x16x32_bf16 v[8:11], v[24:27], v[100:103], v[8:11]
    s_waitcnt vmcnt(7)
    s_add_u32 s35, s69, 36864
    buffer_load_dwordx4 v[100:103], v1, s[44:47], s35 offen offset:1024 nt
    v_and_b32_dpp v20, v4, v16 row_newbcast:14 row_mask:0xf bank_mask:0xf
    v_and_b32_dpp v21, v4, v17 row_newbcast:14 row_mask:0xf bank_mask:0xf
    v_and_b32_dpp v22, v4, v18 row_newbcast:14 row_mask:0xf bank_mask:0xf
    v_and_b32_dpp v23, v4, v19 row_newbcast:14 row_mask:0xf bank_mask:0xf
    s_nop 1
    v_mfma_f32_16x16x32_bf16 v[8:11], v[20:23], v[104:107], v[8:11]
    s_waitcnt vmcnt(7)
    s_add_u32 s35, s69, 36864
    buffer_load_dwordx4 v[104:107], v1, s[44:47], s35 offen offset:2048 nt
    v_and_b32_dpp v24, v4, v16 row_newbcast:15 row_mask:0xf bank_mask:0xf
    v_and_b32_dpp v25, v4, v17 row_newbcast:15 row_mask:0xf bank_mask:0xf
    v_and_b32_dpp v26, v4, v18 row_newbcast:15 row_mask:0xf bank_mask:0xf
    v_and_b32_dpp v27, v4, v19 row_newbcast:15 row_mask:0xf bank_mask:0xf
    s_nop 1
    v_mfma_f32_16x16x32_bf16 v[8:11], v[24:27], v[108:111], v[8:11]
    s_waitcnt vmcnt(7)
    s_add_u32 s35, s69, 36864
    buffer_load_dwordx4 v[108:111], v1, s[44:47], s35 offen offset:3072 nt
    v_and_b32_dpp v20, v30, v16 row_newbcast:0 row_mask:0xf bank_mask:0xf
    v_and_b32_dpp v21, v30, v17 row_newbcast:0 row_mask:0xf bank_mask:0xf
    v_and_b32_dpp v22, v30, v18 row_newbcast:0 row_mask:0xf bank_mask:0xf
    v_and_b32_dpp v23, v30, v19 row_newbcast:0 row_mask:0xf bank_mask:0xf
    s_nop 1
    v_mfma_f32_16x16x32_bf16 v[8:11], v[20:23], v[112:115], v[8:11]
    s_waitcnt vmcnt(7)
    s_add_u32 s35, s69, 65536
    buffer_load_dwordx4 v[112:115], v1, s[44:47], s35 offen offset:0 nt
    v_and_b32_dpp v24, v30, v16 row_newbcast:1 row_mask:0xf bank_mask:0xf
    v_and_b32_dpp v25, v30, v17 row_newbcast:1 row_mask:0xf bank_mask:0xf
    v_and_b32_dpp v26, v30, v18 row_newbcast:1 row_mask:0xf bank_mask:0xf
    v_and_b32_dpp v27, v30, v19 row_newbcast:1 row_mask:0xf bank_mask:0xf
    s_nop 1
    v_mfma_f32_16x16x32_bf16 v[8:11], v[24:27], v[116:119], v[8:11]
    s_waitcnt vmcnt(7)
    s_add_u32 s35, s69, 65536
    buffer_load_dwordx4 v[116:119], v1, s[44:47], s35 offen offset:1024 nt
    v_and_b32_dpp v20, v30, v16 row_newbcast:2 row_mask:0xf bank_mask:0xf
    v_and_b32_dpp v21, v30, v17 row_newbcast:2 row_mask:0xf bank_mask:0xf
    v_and_b32_dpp v22, v30, v18 row_newbcast:2 row_mask:0xf bank_mask:0xf
    v_and_b32_dpp v23, v30, v19 row_newbcast:2 row_mask:0xf bank_mask:0xf
    s_nop 1
    v_mfma_f32_16x16x32_bf16 v[8:11], v[20:23], v[120:123], v[8:11]
    s_waitcnt vmcnt(7)
    s_add_u32 s35, s69, 65536
    buffer_load_dwordx4 v[120:123], v1, s[44:47], s35 offen offset:2048 nt
    v_and_b32_dpp v24, v30, v16 row_newbcast:3 row_mask:0xf bank_mask:0xf
    v_and_b32_dpp v25, v30, v17 row_newbcast:3 row_mask:0xf bank_mask:0xf
    v_and_b32_dpp v26, v30, v18 row_newbcast:3 row_mask:0xf bank_mask:0xf
    v_and_b32_dpp v27, v30, v19 row_newbcast:3 row_mask:0xf bank_mask:0xf
    s_nop 1
    v_mfma_f32_16x16x32_bf16 v[8:11], v[24:27], v[124:127], v[8:11]
    s_waitcnt vmcnt(7)
    s_add_u32 s35, s69, 65536
    buffer_load_dwordx4 v[124:127], v1, s[44:47], s35 offen offset:3072 nt
    v_and_b32_dpp v20, v30, v16 row_newbcast:4 row_mask:0xf bank_mask:0xf
    v_and_b32_dpp v21, v30, v17 row_newbcast:4 row_mask:0xf bank_mask:0xf
    v_and_b32_dpp v22, v30, v18 row_newbcast:4 row_mask:0xf bank_mask:0xf
    v_and_b32_dpp v23, v30, v19 row_newbcast:4 row_mask:0xf bank_mask:0xf
    s_nop 1
    v_mfma_f32_16x16x32_bf16 v[8:11], v[20:23], v[128:131], v[8:11]
    s_waitcnt vmcnt(7)
    s_add_u32 s35, s69, 69632
    buffer_load_dwordx4 v[128:131], v1, s[44:47], s35 offen offset:0 nt
    v_and_b32_dpp v24, v30, v16 row_newbcast:5 row_mask:0xf bank_mask:0xf
    v_and_b32_dpp v25, v30, v17 row_newbcast:5 row_mask:0xf bank_mask:0xf
    v_and_b32_dpp v26, v30, v18 row_newbcast:5 row_mask:0xf bank_mask:0xf
    v_and_b32_dpp v27, v30, v19 row_newbcast:5 row_mask:0xf bank_mask:0xf
    s_nop 1
    v_mfma_f32_16x16x32_bf16 v[8:11], v[24:27], v[132:135], v[8:11]
    s_waitcnt vmcnt(7)
    s_add_u32 s35, s69, 69632
    buffer_load_dwordx4 v[132:135], v1, s[44:47], s35 offen offset:1024 nt
    v_and_b32_dpp v20, v30, v16 row_newbcast:6 row_mask:0xf bank_mask:0xf
    v_and_b32_dpp v21, v30, v17 row_newbcast:6 row_mask:0xf bank_mask:0xf
    v_and_b32_dpp v22, v30, v18 row_newbcast:6 row_mask:0xf bank_mask:0xf
    v_and_b32_dpp v23, v30, v19 row_newbcast:6 row_mask:0xf bank_mask:0xf
    s_nop 1
    v_mfma_f32_16x16x32_bf16 v[8:11], v[20:23], v[136:139], v[8:11]
    s_waitcnt vmcnt(7)
    s_add_u32 s35, s69, 69632
    buffer_load_dwordx4 v[136:139], v1, s[44:47], s35 offen offset:2048 nt
    v_and_b32_dpp v24, v30, v16 row_newbcast:7 row_mask:0xf bank_mask:0xf
    v_and_b32_dpp v25, v30, v17 row_newbcast:7 row_mask:0xf bank_mask:0xf
    v_and_b32_dpp v26, v30, v18 row_newbcast:7 row_mask:0xf bank_mask:0xf
    v_and_b32_dpp v27, v30, v19 row_newbcast:7 row_mask:0xf bank_mask:0xf
    s_nop 1
    v_mfma_f32_16x16x32_bf16 v[8:11], v[24:27], v[140:143], v[8:11]
    s_waitcnt vmcnt(7)
    s_add_u32 s35, s69, 69632
    buffer_load_dwordx4 v[140:143], v1, s[44:47], s35 offen offset:3072 nt
    v_and_b32_dpp v20, v30, v16 row_newbcast:8 row_mask:0xf bank_mask:0xf
    v_and_b32_dpp v21, v30, v17 row_newbcast:8 row_mask:0xf bank_mask:0xf
    v_and_b32_dpp v22, v30, v18 row_newbcast:8 row_mask:0xf bank_mask:0xf
    v_and_b32_dpp v23, v30, v19 row_newbcast:8 row_mask:0xf bank_mask:0xf
    s_nop 1
    v_mfma_f32_16x16x32_bf16 v[8:11], v[20:23], v[144:147], v[8:11]
    s_waitcnt vmcnt(7)
    s_add_u32 s35, s69, 98304
    buffer_load_dwordx4 v[144:147], v1, s[44:47], s35 offen offset:0 nt
    v_and_b32_dpp v24, v30, v16 row_newbcast:9 row_mask:0xf bank_mask:0xf
    v_and_b32_dpp v25, v30, v17 row_newbcast:9 row_mask:0xf bank_mask:0xf
    v_and_b32_dpp v26, v30, v18 row_newbcast:9 row_mask:0xf bank_mask:0xf
    v_and_b32_dpp v27, v30, v19 row_newbcast:9 row_mask:0xf bank_mask:0xf
    s_nop 1
    v_mfma_f32_16x16x32_bf16 v[8:11], v[24:27], v[148:151], v[8:11]
    s_waitcnt vmcnt(7)
    s_add_u32 s35, s69, 98304
    buffer_load_dwordx4 v[148:151], v1, s[44:47], s35 offen offset:1024 nt
    v_and_b32_dpp v20, v30, v16 row_newbcast:10 row_mask:0xf bank_mask:0xf
    v_and_b32_dpp v21, v30, v17 row_newbcast:10 row_mask:0xf bank_mask:0xf
    v_and_b32_dpp v22, v30, v18 row_newbcast:10 row_mask:0xf bank_mask:0xf
    v_and_b32_dpp v23, v30, v19 row_newbcast:10 row_mask:0xf bank_mask:0xf
    s_nop 1
    v_mfma_f32_16x16x32_bf16 v[8:11], v[20:23], v[152:155], v[8:11]
    s_waitcnt vmcnt(7)
    s_add_u32 s35, s69, 98304
    buffer_load_dwordx4 v[152:155], v1, s[44:47], s35 offen offset:2048 nt
    v_and_b32_dpp v24, v30, v16 row_newbcast:11 row_mask:0xf bank_mask:0xf
    v_and_b32_dpp v25, v30, v17 row_newbcast:11 row_mask:0xf bank_mask:0xf
    v_and_b32_dpp v26, v30, v18 row_newbcast:11 row_mask:0xf bank_mask:0xf
    v_and_b32_dpp v27, v30, v19 row_newbcast:11 row_mask:0xf bank_mask:0xf
    s_nop 1
    v_mfma_f32_16x16x32_bf16 v[8:11], v[24:27], v[156:159], v[8:11]
    s_waitcnt vmcnt(7)
    s_add_u32 s35, s69, 98304
    buffer_load_dwordx4 v[156:159], v1, s[44:47], s35 offen offset:3072 nt
    v_and_b32_dpp v20, v30, v16 row_newbcast:12 row_mask:0xf bank_mask:0xf
    v_and_b32_dpp v21, v30, v17 row_newbcast:12 row_mask:0xf bank_mask:0xf
    v_and_b32_dpp v22, v30, v18 row_newbcast:12 row_mask:0xf bank_mask:0xf
    v_and_b32_dpp v23, v30, v19 row_newbcast:12 row_mask:0xf bank_mask:0xf
    s_nop 1
    v_mfma_f32_16x16x32_bf16 v[8:11], v[20:23], v[160:163], v[8:11]
    s_waitcnt vmcnt(7)
    s_add_u32 s35, s69, 102400
    buffer_load_dwordx4 v[160:163], v1, s[44:47], s35 offen offset:0 nt
    v_and_b32_dpp v24, v30, v16 row_newbcast:13 row_mask:0xf bank_mask:0xf
    v_and_b32_dpp v25, v30, v17 row_newbcast:13 row_mask:0xf bank_mask:0xf
    v_and_b32_dpp v26, v30, v18 row_newbcast:13 row_mask:0xf bank_mask:0xf
    v_and_b32_dpp v27, v30, v19 row_newbcast:13 row_mask:0xf bank_mask:0xf
    s_nop 1
    v_mfma_f32_16x16x32_bf16 v[8:11], v[24:27], v[164:167], v[8:11]
    s_waitcnt vmcnt(7)
    s_add_u32 s35, s69, 102400
    buffer_load_dwordx4 v[164:167], v1, s[44:47], s35 offen offset:1024 nt
    v_and_b32_dpp v20, v30, v16 row_newbcast:14 row_mask:0xf bank_mask:0xf
    v_and_b32_dpp v21, v30, v17 row_newbcast:14 row_mask:0xf bank_mask:0xf
    v_and_b32_dpp v22, v30, v18 row_newbcast:14 row_mask:0xf bank_mask:0xf
    v_and_b32_dpp v23, v30, v19 row_newbcast:14 row_mask:0xf bank_mask:0xf
    s_nop 1
    v_mfma_f32_16x16x32_bf16 v[8:11], v[20:23], v[168:171], v[8:11]
    s_waitcnt vmcnt(7)
    s_add_u32 s35, s69, 102400
    buffer_load_dwordx4 v[168:171], v1, s[44:47], s35 offen offset:2048 nt
    v_and_b32_dpp v24, v30, v16 row_newbcast:15 row_mask:0xf bank_mask:0xf
    v_and_b32_dpp v25, v30, v17 row_newbcast:15 row_mask:0xf bank_mask:0xf
    v_and_b32_dpp v26, v30, v18 row_newbcast:15 row_mask:0xf bank_mask:0xf
    v_and_b32_dpp v27, v30, v19 row_newbcast:15 row_mask:0xf bank_mask:0xf
    s_nop 1
    v_mfma_f32_16x16x32_bf16 v[8:11], v[24:27], v[172:175], v[8:11]
    s_waitcnt vmcnt(7)
    s_add_u32 s35, s69, 102400
    buffer_load_dwordx4 v[172:175], v1, s[44:47], s35 offen offset:3072 nt
    s_add_u32 s69, s69, 131072
    s_sub_u32 s12, s12, 1
    s_cmp_lg_u32 s12, 0
    s_cbranch_scc1 L_vloophi2
L_vskiphi2:
    s_cmp_eq_u32 s9, 0
    s_cbranch_scc1 L_vskiphi
L_vloophi:
    s_nop 1
    s_sub_u32 s13, s13, 1
    s_cmp_lg_u32 s13, 0
    s_cbranch_scc1 L_nphi
    v_mov_b32 v5, 98588
    v_mov_b32 v6, 1
    ds_write_b32 v5, v6
L_nphi:
    s_waitcnt lgkmcnt(0)
    v_sub_f32 v28, v28, v2
    v_mul_f32 v28, s68, v28
    v_exp_f32 v28, v28
    s_nop 0
    v_mul_f32 v28, v28, v3
    v_cvt_pk_bf16_f32 v4, v28, v28
    v_sub_f32 v183, v183, v2
    v_mul_f32 v183, s68, v183
    v_exp_f32 v183, v183
    s_nop 0
    v_mul_f32 v183, v183, v3
    v_cvt_pk_bf16_f32 v30, v183, v183
    v_add_u32 v182, 512, v182
    ds_read_b32 v28, v182
    ds_read_b32 v183, v182 offset:256
    v_and_b32_dpp v20, v4, v16 row_newbcast:0 row_mask:0xf bank_mask:0xf
    v_and_b32_dpp v21, v4, v17 row_newbcast:0 row_mask:0xf bank_mask:0xf
    v_and_b32_dpp v22, v4, v18 row_newbcast:0 row_mask:0xf bank_mask:0xf
    v_and_b32_dpp v23, v4, v19 row_newbcast:0 row_mask:0xf bank_mask:0xf
    s_nop 1
    v_mfma_f32_16x16x32_bf16 v[8:11], v[20:23], v[48:51], v[8:11]
    s_waitcnt vmcnt(5)
    buffer_load_dwordx4 v[48:51], v1, s[44:47], s69 offen offset:0 nt
    v_and_b32_dpp v24, v4, v16 row_newbcast:1 row_mask:0xf bank_mask:0xf
    v_and_b32_dpp v25, v4, v17 row_newbcast:1 row_mask:0xf bank_mask:0xf
    v_and_b32_dpp v26, v4, v18 row_newbcast:1 row_mask:0xf bank_mask:0xf
    v_and_b32_dpp v27, v4, v19 row_newbcast:1 row_mask:0xf bank_mask:0xf
    s_nop 1
    v_mfma_f32_16x16x32_bf16 v[8:11], v[24:27], v[52:55], v[8:11]
    s_waitcnt vmcnt(5)
    buffer_load_dwordx4 v[52:55], v1, s[44:47], s69 offen offset:1024 nt
    v_and_b32_dpp v20, v4, v16 row_newbcast:2 row_mask:0xf bank_mask:0xf
    v_and_b32_dpp v21, v4, v17 row_newbcast:2 row_mask:0xf bank_mask:0xf
    v_and_b32_dpp v22, v4, v18 row_newbcast:2 row_mask:0xf bank_mask:0xf
    v_and_b32_dpp v23, v4, v19 row_newbcast:2 row_mask:0xf bank_mask:0xf
    s_nop 1
    v_mfma_f32_16x16x32_bf16 v[8:11], v[20:23], v[56:59], v[8:11]
    s_waitcnt vmcnt(5)
    buffer_load_dwordx4 v[56:59], v1, s[44:47], s69 offen offset:2048 nt
    v_and_b32_dpp v24, v4, v16 row_newbcast:3 row_mask:0xf bank_mask:0xf
    v_and_b32_dpp v25, v4, v17 row_newbcast:3 row_mask:0xf bank_mask:0xf
    v_and_b32_dpp v26, v4, v18 row_newbcast:3 row_mask:0xf bank_mask:0xf
    v_and_b32_dpp v27, v4, v19 row_newbcast:3 row_mask:0xf bank_mask:0xf
    s_nop 1
    v_mfma_f32_16x16x32_bf16 v[8:11], v[24:27], v[60:63], v[8:11]
    s_waitcnt vmcnt(5)
    buffer_load_dwordx4 v[60:63], v1, s[44:47], s69 offen offset:3072 nt
    v_and_b32_dpp v20, v4, v16 row_newbcast:4 row_mask:0xf bank_mask:0xf
    v_and_b32_dpp v21, v4, v17 row_newbcast:4 row_mask:0xf bank_mask:0xf
    v_and_b32_dpp v22, v4, v18 row_newbcast:4 row_mask:0xf bank_mask:0xf
    v_and_b32_dpp v23, v4, v19 row_newbcast:4 row_mask:0xf bank_mask:0xf
    s_nop 1
    v_mfma_f32_16x16x32_bf16 v[8:11], v[20:23], v[64:67], v[8:11]
    s_waitcnt vmcnt(5)
    s_add_u32 s35, s69, 4096
    buffer_load_dwordx4 v[64:67], v1, s[44:47], s35 offen offset:0 nt
    v_and_b32_dpp v24, v4, v16 row_newbcast:5 row_mask:0xf bank_mask:0xf
    v_and_b32_dpp v25, v4, v17 row_newbcast:5 row_mask:0xf bank_mask:0xf
    v_and_b32_dpp v26, v4, v18 row_newbcast:5 row_mask:0xf bank_mask:0xf
    v_and_b32_dpp v27, v4, v19 row_newbcast:5 row_mask:0xf bank_mask:0xf
    s_nop 1
    v_mfma_f32_16x16x32_bf16 v[8:11], v[24:27], v[68:71], v[8:11]
    s_waitcnt vmcnt(5)
    s_add_u32 s35, s69, 4096
    buffer_load_dwordx4 v[68:71], v1, s[44:47], s35 offen offset:1024 nt
    v_and_b32_dpp v20, v4, v16 row_newbcast:6 row_mask:0xf bank_mask:0xf
    v_and_b32_dpp v21, v4, v17 row_newbcast:6 row_mask:0xf bank_mask:0xf
    v_and_b32_dpp v22, v4, v18 row_newbcast:6 row_mask:0xf bank_mask:0xf
    v_and_b32_dpp v23, v4, v19 row_newbcast:6 row_mask:0xf bank_mask:0xf
    s_nop 1
    v_mfma_f32_16x16x32_bf16 v[8:11], v[20:23], v[72:75], v[8:11]
    s_waitcnt vmcnt(5)
    s_add_u32 s35, s69, 4096
    buffer_load_dwordx4 v[72:75], v1, s[44:47], s35 offen offset:2048 nt
    v_and_b32_dpp v24, v4, v16 row_newbcast:7 row_mask:0xf bank_mask:0xf
    v_and_b32_dpp v25, v4, v17 row_newbcast:7 row_mask:0xf bank_mask:0xf
    v_and_b32_dpp v26, v4, v18 row_newbcast:7 row_mask:0xf bank_mask:0xf
    v_and_b32_dpp v27, v4, v19 row_newbcast:7 row_mask:0xf bank_mask:0xf
    s_nop 1
    v_mfma_f32_16x16x32_bf16 v[8:11], v[24:27], v[76:79], v[8:11]
    s_waitcnt vmcnt(5)
    s_add_u32 s35, s69, 4096
    buffer_load_dwordx4 v[76:79], v1, s[44:47], s35 offen offset:3072 nt
    v_and_b32_dpp v20, v4, v16 row_newbcast:8 row_mask:0xf bank_mask:0xf
    v_and_b32_dpp v21, v4, v17 row_newbcast:8 row_mask:0xf bank_mask:0xf
    v_and_b32_dpp v22, v4, v18 row_newbcast:8 row_mask:0xf bank_mask:0xf
    v_and_b32_dpp v23, v4, v19 row_newbcast:8 row_mask:0xf bank_mask:0xf
    s_nop 1
    v_mfma_f32_16x16x32_bf16 v[8:11], v[20:23], v[80:83], v[8:11]
    s_waitcnt vmcnt(5)
    s_add_u32 s35, s69, 32768
    buffer_load_dwordx4 v[80:83], v1, s[44:47], s35 offen offset:0 nt
    v_and_b32_dpp v24, v4, v16 row_newbcast:9 row_mask:0xf bank_mask:0xf
    v_and_b32_dpp v25, v4, v17 row_newbcast:9 row_mask:0xf bank_mask:0xf
    v_and_b32_dpp v26, v4, v18 row_newbcast:9 row_mask:0xf bank_mask:0xf
    v_and_b32_dpp v27, v4, v19 row_newbcast:9 row_mask:0xf bank_mask:0xf
    s_nop 1
    v_mfma_f32_16x16x32_bf16 v[8:11], v[24:27], v[84:87], v[8:11]
    s_waitcnt vmcnt(5)
    s_add_u32 s35, s69, 32768
    buffer_load_dwordx4 v[84:87], v1, s[44:47], s35 offen offset:1024 nt
    v_and_b32_dpp v20, v4, v16 row_newbcast:10 row_mask:0xf bank_mask:0xf
    v_and_b32_dpp v21, v4, v17 row_newbcast:10 row_mask:0xf bank_mask:0xf
    v_and_b32_dpp v22, v4, v18 row_newbcast:10 row_mask:0xf bank_mask:0xf
    v_and_b32_dpp v23, v4, v19 row_newbcast:10 row_mask:0xf bank_mask:0xf
    s_nop 1
    v_mfma_f32_16x16x32_bf16 v[8:11], v[20:23], v[88:91], v[8:11]
    s_waitcnt vmcnt(5)
    s_add_u32 s35, s69, 32768
    buffer_load_dwordx4 v[88:91], v1, s[44:47], s35 offen offset:2048 nt
    v_and_b32_dpp v24, v4, v16 row_newbcast:11 row_mask:0xf bank_mask:0xf
    v_and_b32_dpp v25, v4, v17 row_newbcast:11 row_mask:0xf bank_mask:0xf
    v_and_b32_dpp v26, v4, v18 row_newbcast:11 row_mask:0xf bank_mask:0xf
    v_and_b32_dpp v27, v4, v19 row_newbcast:11 row_mask:0xf bank_mask:0xf
    s_nop 1
    v_mfma_f32_16x16x32_bf16 v[8:11], v[24:27], v[92:95], v[8:11]
    s_waitcnt vmcnt(5)
    s_add_u32 s35, s69, 32768
    buffer_load_dwordx4 v[92:95], v1, s[44:47], s35 offen offset:3072 nt
    v_and_b32_dpp v20, v4, v16 row_newbcast:12 row_mask:0xf bank_mask:0xf
    v_and_b32_dpp v21, v4, v17 row_newbcast:12 row_mask:0xf bank_mask:0xf
    v_and_b32_dpp v22, v4, v18 row_newbcast:12 row_mask:0xf bank_mask:0xf
    v_and_b32_dpp v23, v4, v19 row_newbcast:12 row_mask:0xf bank_mask:0xf
    s_nop 1
    v_mfma_f32_16x16x32_bf16 v[8:11], v[20:23], v[96:99], v[8:11]
    s_waitcnt vmcnt(5)
    s_add_u32 s35, s69, 36864
    buffer_load_dwordx4 v[96:99], v1, s[44:47], s35 offen offset:0 nt
    v_and_b32_dpp v24, v4, v16 row_newbcast:13 row_mask:0xf bank_mask:0xf
    v_and_b32_dpp v25, v4, v17 row_newbcast:13 row_mask:0xf bank_mask:0xf
    v_and_b32_dpp v26, v4, v18 row_newbcast:13 row_mask:0xf bank_mask:0xf
    v_and_b32_dpp v27, v4, v19 row_newbcast:13 row_mask:0xf bank_mask:0xf
    s_nop 1
    v_mfma_f32_16x16x32_bf16 v[8:11], v[24:27], v[100:103], v[8:11]
    s_waitcnt vmcnt(5)
    s_add_u32 s35, s69, 36864
    buffer_load_dwordx4 v[100:103], v1, s[44:47], s35 offen offset:1024 nt
    v_and_b32_dpp v20, v4, v16 row_newbcast:14 row_mask:0xf bank_mask:0xf
    v_and_b32_dpp v21, v4, v17 row_newbcast:14 row_mask:0xf bank_mask:0xf
    v_and_b32_dpp v22, v4, v18 row_newbcast:14 row_mask:0xf bank_mask:0xf
    v_and_b32_dpp v23, v4, v19 row_newbcast:14 row_mask:0xf bank_mask:0xf
    s_nop 1
    v_mfma_f32_16x16x32_bf16 v[8:11], v[20:23], v[104:107], v[8:11]
    s_waitcnt vmcnt(5)
    s_add_u32 s35, s69, 36864
    buffer_load_dwordx4 v[104:107], v1, s[44:47], s35 offen offset:2048 nt
    v_and_b32_dpp v24, v4, v16 row_newbcast:15 row_mask:0xf bank_mask:0xf
    v_and_b32_dpp v25, v4, v17 row_newbcast:15 row_mask:0xf bank_mask:0xf
    v_and_b32_dpp v26, v4, v18 row_newbcast:15 row_mask:0xf bank_mask:0xf
    v_and_b32_dpp v27, v4, v19 row_newbcast:15 row_mask:0xf bank_mask:0xf
    s_nop 1
    v_mfma_f32_16x16x32_bf16 v[8:11], v[24:27], v[108:111], v[8:11]
    s_waitcnt vmcnt(5)
    s_add_u32 s35, s69, 36864
    buffer_load_dwordx4 v[108:111], v1, s[44:47], s35 offen offset:3072 nt
    v_and_b32_dpp v20, v30, v16 row_newbcast:0 row_mask:0xf bank_mask:0xf
    v_and_b32_dpp v21, v30, v17 row_newbcast:0 row_mask:0xf bank_mask:0xf
    v_and_b32_dpp v22, v30, v18 row_newbcast:0 row_mask:0xf bank_mask:0xf
    v_and_b32_dpp v23, v30, v19 row_newbcast:0 row_mask:0xf bank_mask:0xf
    s_nop 1
    v_mfma_f32_16x16x32_bf16 v[8:11], v[20:23], v[112:115], v[8:11]
    s_waitcnt vmcnt(5)
    s_add_u32 s35, s69, 65536
    buffer_load_dwordx4 v[112:115], v1, s[44:47], s35 offen offset:0 nt
    v_and_b32_dpp v24, v30, v16 row_newbcast:1 row_mask:0xf bank_mask:0xf
    v_and_b32_dpp v25, v30, v17 row_newbcast:1 row_mask:0xf bank_mask:0xf
    v_and_b32_dpp v26, v30, v18 row_newbcast:1 row_mask:0xf bank_mask:0xf
    v_and_b32_dpp v27, v30, v19 row_newbcast:1 row_mask:0xf bank_mask:0xf
    s_nop 1
    v_mfma_f32_16x16x32_bf16 v[8:11], v[24:27], v[116:119], v[8:11]
    s_waitcnt vmcnt(5)
    s_add_u32 s35, s69, 65536
    buffer_load_dwordx4 v[116:119], v1, s[44:47], s35 offen offset:1024 nt
    v_and_b32_dpp v20, v30, v16 row_newbcast:2 row_mask:0xf bank_mask:0xf
    v_and_b32_dpp v21, v30, v17 row_newbcast:2 row_mask:0xf bank_mask:0xf
    v_and_b32_dpp v22, v30, v18 row_newbcast:2 row_mask:0xf bank_mask:0xf
    v_and_b32_dpp v23, v30, v19 row_newbcast:2 row_mask:0xf bank_mask:0xf
    s_nop 1
    v_mfma_f32_16x16x32_bf16 v[8:11], v[20:23], v[120:123], v[8:11]
    s_waitcnt vmcnt(5)
    s_add_u32 s35, s69, 65536
    buffer_load_dwordx4 v[120:123], v1, s[44:47], s35 offen offset:2048 nt
    v_and_b32_dpp v24, v30, v16 row_newbcast:3 row_mask:0xf bank_mask:0xf
    v_and_b32_dpp v25, v30, v17 row_newbcast:3 row_mask:0xf bank_mask:0xf
    v_and_b32_dpp v26, v30, v18 row_newbcast:3 row_mask:0xf bank_mask:0xf
    v_and_b32_dpp v27, v30, v19 row_newbcast:3 row_mask:0xf bank_mask:0xf
    s_nop 1
    v_mfma_f32_16x16x32_bf16 v[8:11], v[24:27], v[124:127], v[8:11]
    s_waitcnt vmcnt(5)
    s_add_u32 s35, s69, 65536
    buffer_load_dwordx4 v[124:127], v1, s[44:47], s35 offen offset:3072 nt
    v_and_b32_dpp v20, v30, v16 row_newbcast:4 row_mask:0xf bank_mask:0xf
    v_and_b32_dpp v21, v30, v17 row_newbcast:4 row_mask:0xf bank_mask:0xf
    v_and_b32_dpp v22, v30, v18 row_newbcast:4 row_mask:0xf bank_mask:0xf
    v_and_b32_dpp v23, v30, v19 row_newbcast:4 row_mask:0xf bank_mask:0xf
    s_nop 1
    v_mfma_f32_16x16x32_bf16 v[8:11], v[20:23], v[128:131], v[8:11]
    s_waitcnt vmcnt(5)
    s_add_u32 s35, s69, 69632
    buffer_load_dwordx4 v[128:131], v1, s[44:47], s35 offen offset:0 nt
    v_and_b32_dpp v24, v30, v16 row_newbcast:5 row_mask:0xf bank_mask:0xf
    v_and_b32_dpp v25, v30, v17 row_newbcast:5 row_mask:0xf bank_mask:0xf
    v_and_b32_dpp v26, v30, v18 row_newbcast:5 row_mask:0xf bank_mask:0xf
    v_and_b32_dpp v27, v30, v19 row_newbcast:5 row_mask:0xf bank_mask:0xf
    s_nop 1
    v_mfma_f32_16x16x32_bf16 v[8:11], v[24:27], v[132:135], v[8:11]
    s_waitcnt vmcnt(5)
    s_add_u32 s35, s69, 69632
    buffer_load_dwordx4 v[132:135], v1, s[44:47], s35 offen offset:1024 nt
    v_and_b32_dpp v20, v30, v16 row_newbcast:6 row_mask:0xf bank_mask:0xf
    v_and_b32_dpp v21, v30, v17 row_newbcast:6 row_mask:0xf bank_mask:0xf
    v_and_b32_dpp v22, v30, v18 row_newbcast:6 row_mask:0xf bank_mask:0xf
    v_and_b32_dpp v23, v30, v19 row_newbcast:6 row_mask:0xf bank_mask:0xf
    s_nop 1
    v_mfma_f32_16x16x32_bf16 v[8:11], v[20:23], v[136:139], v[8:11]
    s_waitcnt vmcnt(5)
    s_add_u32 s35, s69, 69632
    buffer_load_dwordx4 v[136:139], v1, s[44:47], s35 offen offset:2048 nt
    v_and_b32_dpp v24, v30, v16 row_newbcast:7 row_mask:0xf bank_mask:0xf
    v_and_b32_dpp v25, v30, v17 row_newbcast:7 row_mask:0xf bank_mask:0xf
    v_and_b32_dpp v26, v30, v18 row_newbcast:7 row_mask:0xf bank_mask:0xf
    v_and_b32_dpp v27, v30, v19 row_newbcast:7 row_mask:0xf bank_mask:0xf
    s_nop 1
    v_mfma_f32_16x16x32_bf16 v[8:11], v[24:27], v[140:143], v[8:11]
    s_waitcnt vmcnt(5)
    s_add_u32 s35, s69, 69632
    buffer_load_dwordx4 v[140:143], v1, s[44:47], s35 offen offset:3072 nt
    v_and_b32_dpp v20, v30, v16 row_newbcast:8 row_mask:0xf bank_mask:0xf
    v_and_b32_dpp v21, v30, v17 row_newbcast:8 row_mask:0xf bank_mask:0xf
    v_and_b32_dpp v22, v30, v18 row_newbcast:8 row_mask:0xf bank_mask:0xf
    v_and_b32_dpp v23, v30, v19 row_newbcast:8 row_mask:0xf bank_mask:0xf
    s_nop 1
    v_mfma_f32_16x16x32_bf16 v[8:11], v[20:23], v[144:147], v[8:11]
    s_waitcnt vmcnt(5)
    s_add_u32 s35, s69, 98304
    buffer_load_dwordx4 v[144:147], v1, s[44:47], s35 offen offset:0 nt
    v_and_b32_dpp v24, v30, v16 row_newbcast:9 row_mask:0xf bank_mask:0xf
    v_and_b32_dpp v25, v30, v17 row_newbcast:9 row_mask:0xf bank_mask:0xf
    v_and_b32_dpp v26, v30, v18 row_newbcast:9 row_mask:0xf bank_mask:0xf
    v_and_b32_dpp v27, v30, v19 row_newbcast:9 row_mask:0xf bank_mask:0xf
    s_nop 1
    v_mfma_f32_16x16x32_bf16 v[8:11], v[24:27], v[148:151], v[8:11]
    s_waitcnt vmcnt(5)
    s_add_u32 s35, s69, 98304
    buffer_load_dwordx4 v[148:151], v1, s[44:47], s35 offen offset:1024 nt
    v_and_b32_dpp v20, v30, v16 row_newbcast:10 row_mask:0xf bank_mask:0xf
    v_and_b32_dpp v21, v30, v17 row_newbcast:10 row_mask:0xf bank_mask:0xf
    v_and_b32_dpp v22, v30, v18 row_newbcast:10 row_mask:0xf bank_mask:0xf
    v_and_b32_dpp v23, v30, v19 row_newbcast:10 row_mask:0xf bank_mask:0xf
    s_nop 1
    v_mfma_f32_16x16x32_bf16 v[8:11], v[20:23], v[152:155], v[8:11]
    s_waitcnt vmcnt(5)
    s_add_u32 s35, s69, 98304
    buffer_load_dwordx4 v[152:155], v1, s[44:47], s35 offen offset:2048 nt
    v_and_b32_dpp v24, v30, v16 row_newbcast:11 row_mask:0xf bank_mask:0xf
    v_and_b32_dpp v25, v30, v17 row_newbcast:11 row_mask:0xf bank_mask:0xf
    v_and_b32_dpp v26, v30, v18 row_newbcast:11 row_mask:0xf bank_mask:0xf
    v_and_b32_dpp v27, v30, v19 row_newbcast:11 row_mask:0xf bank_mask:0xf
    s_nop 1
    v_mfma_f32_16x16x32_bf16 v[8:11], v[24:27], v[156:159], v[8:11]
    s_waitcnt vmcnt(5)
    s_add_u32 s35, s69, 98304
    buffer_load_dwordx4 v[156:159], v1, s[44:47], s35 offen offset:3072 nt
    v_and_b32_dpp v20, v30, v16 row_newbcast:12 row_mask:0xf bank_mask:0xf
    v_and_b32_dpp v21, v30, v17 row_newbcast:12 row_mask:0xf bank_mask:0xf
    v_and_b32_dpp v22, v30, v18 row_newbcast:12 row_mask:0xf bank_mask:0xf
    v_and_b32_dpp v23, v30, v19 row_newbcast:12 row_mask:0xf bank_mask:0xf
    s_nop 1
    v_mfma_f32_16x16x32_bf16 v[8:11], v[20:23], v[160:163], v[8:11]
    s_waitcnt vmcnt(5)
    s_add_u32 s35, s69, 102400
    buffer_load_dwordx4 v[160:163], v1, s[44:47], s35 offen offset:0 nt
    v_and_b32_dpp v24, v30, v16 row_newbcast:13 row_mask:0xf bank_mask:0xf
    v_and_b32_dpp v25, v30, v17 row_newbcast:13 row_mask:0xf bank_mask:0xf
    v_and_b32_dpp v26, v30, v18 row_newbcast:13 row_mask:0xf bank_mask:0xf
    v_and_b32_dpp v27, v30, v19 row_newbcast:13 row_mask:0xf bank_mask:0xf
    s_nop 1
    v_mfma_f32_16x16x32_bf16 v[8:11], v[24:27], v[164:167], v[8:11]
    s_waitcnt vmcnt(5)
    s_add_u32 s35, s69, 102400
    buffer_load_dwordx4 v[164:167], v1, s[44:47], s35 offen offset:1024 nt
    v_and_b32_dpp v20, v30, v16 row_newbcast:14 row_mask:0xf bank_mask:0xf
    v_and_b32_dpp v21, v30, v17 row_newbcast:14 row_mask:0xf bank_mask:0xf
    v_and_b32_dpp v22, v30, v18 row_newbcast:14 row_mask:0xf bank_mask:0xf
    v_and_b32_dpp v23, v30, v19 row_newbcast:14 row_mask:0xf bank_mask:0xf
    s_nop 1
    v_mfma_f32_16x16x32_bf16 v[8:11], v[20:23], v[168:171], v[8:11]
    s_waitcnt vmcnt(5)
    s_add_u32 s35, s69, 102400
    buffer_load_dwordx4 v[168:171], v1, s[44:47], s35 offen offset:2048 nt
    v_and_b32_dpp v24, v30, v16 row_newbcast:15 row_mask:0xf bank_mask:0xf
    v_and_b32_dpp v25, v30, v17 row_newbcast:15 row_mask:0xf bank_mask:0xf
    v_and_b32_dpp v26, v30, v18 row_newbcast:15 row_mask:0xf bank_mask:0xf
    v_and_b32_dpp v27, v30, v19 row_newbcast:15 row_mask:0xf bank_mask:0xf
    s_nop 1
    v_mfma_f32_16x16x32_bf16 v[8:11], v[24:27], v[172:175], v[8:11]
    s_waitcnt vmcnt(5)
    s_add_u32 s35, s69, 102400
    buffer_load_dwordx4 v[172:175], v1, s[44:47], s35 offen offset:3072 nt
    s_add_u32 s69, s69, 131072
    s_sub_u32 s9, s9, 1
    s_cmp_lg_u32 s9, 0
    s_cbranch_scc1 L_vloophi
L_vskiphi:
    s_cmp_eq_u32 s10, 0
    s_cbranch_scc1 L_vskiplo
L_vlooplo:
    s_nop 1
    s_sub_u32 s13, s13, 1
    s_cmp_lg_u32 s13, 0
    s_cbranch_scc1 L_nplo
    v_mov_b32 v5, 98588
    v_mov_b32 v6, 1
    ds_write_b32 v5, v6
L_nplo:
    s_waitcnt lgkmcnt(0)
    v_sub_f32 v28, v28, v2
    v_mul_f32 v28, s68, v28
    v_exp_f32 v28, v28
    s_nop 0
    v_mul_f32 v28, v28, v3
    v_cvt_pk_bf16_f32 v4, v28, v28
    v_sub_f32 v183, v183, v2
    v_mul_f32 v183, s68, v183
    v_exp_f32 v183, v183
    s_nop 0
    v_mul_f32 v183, v183, v3
    v_cvt_pk_bf16_f32 v30, v183, v183
    v_add_u32 v182, 512, v182
    ds_read_b32 v28, v182
    ds_read_b32 v183, v182 offset:256
    v_and_b32_dpp v20, v4, v16 row_newbcast:0 row_mask:0xf bank_mask:0xf
    v_and_b32_dpp v21, v4, v17 row_newbcast:0 row_mask:0xf bank_mask:0xf
    v_and_b32_dpp v22, v4, v18 row_newbcast:0 row_mask:0xf bank_mask:0xf
    v_and_b32_dpp v23, v4, v19 row_newbcast:0 row_mask:0xf bank_mask:0xf
    s_nop 1
    v_mfma_f32_16x16x32_bf16 v[8:11], v[20:23], v[48:51], v[8:11]
    s_waitcnt vmcnt(3)
    buffer_load_dwordx4 v[48:51], v1, s[44:47], s69 offen offset:0 nt
    v_and_b32_dpp v24, v4, v16 row_newbcast:1 row_mask:0xf bank_mask:0xf
    v_and_b32_dpp v25, v4, v17 row_newbcast:1 row_mask:0xf bank_mask:0xf
    v_and_b32_dpp v26, v4, v18 row_newbcast:1 row_mask:0xf bank_mask:0xf
    v_and_b32_dpp v27, v4, v19 row_newbcast:1 row_mask:0xf bank_mask:0xf
    s_nop 1
    v_mfma_f32_16x16x32_bf16 v[8:11], v[24:27], v[52:55], v[8:11]
    s_waitcnt vmcnt(3)
    buffer_load_dwordx4 v[52:55], v1, s[44:47], s69 offen offset:1024 nt
    v_and_b32_dpp v20, v4, v16 row_newbcast:2 row_mask:0xf bank_mask:0xf
    v_and_b32_dpp v21, v4, v17 row_newbcast:2 row_mask:0xf bank_mask:0xf
    v_and_b32_dpp v22, v4, v18 row_newbcast:2 row_mask:0xf bank_mask:0xf
    v_and_b32_dpp v23, v4, v19 row_newbcast:2 row_mask:0xf bank_mask:0xf
    s_nop 1
    v_mfma_f32_16x16x32_bf16 v[8:11], v[20:23], v[56:59], v[8:11]
    s_waitcnt vmcnt(3)
    buffer_load_dwordx4 v[56:59], v1, s[44:47], s69 offen offset:2048 nt
    v_and_b32_dpp v24, v4, v16 row_newbcast:3 row_mask:0xf bank_mask:0xf
    v_and_b32_dpp v25, v4, v17 row_newbcast:3 row_mask:0xf bank_mask:0xf
    v_and_b32_dpp v26, v4, v18 row_newbcast:3 row_mask:0xf bank_mask:0xf
    v_and_b32_dpp v27, v4, v19 row_newbcast:3 row_mask:0xf bank_mask:0xf
    s_nop 1
    v_mfma_f32_16x16x32_bf16 v[8:11], v[24:27], v[60:63], v[8:11]
    s_waitcnt vmcnt(3)
    buffer_load_dwordx4 v[60:63], v1, s[44:47], s69 offen offset:3072 nt
    v_and_b32_dpp v20, v4, v16 row_newbcast:4 row_mask:0xf bank_mask:0xf
    v_and_b32_dpp v21, v4, v17 row_newbcast:4 row_mask:0xf bank_mask:0xf
    v_and_b32_dpp v22, v4, v18 row_newbcast:4 row_mask:0xf bank_mask:0xf
    v_and_b32_dpp v23, v4, v19 row_newbcast:4 row_mask:0xf bank_mask:0xf
    s_nop 1
    v_mfma_f32_16x16x32_bf16 v[8:11], v[20:23], v[64:67], v[8:11]
    s_waitcnt vmcnt(3)
    s_add_u32 s35, s69, 4096
    buffer_load_dwordx4 v[64:67], v1, s[44:47], s35 offen offset:0 nt
    v_and_b32_dpp v24, v4, v16 row_newbcast:5 row_mask:0xf bank_mask:0xf
    v_and_b32_dpp v25, v4, v17 row_newbcast:5 row_mask:0xf bank_mask:0xf
    v_and_b32_dpp v26, v4, v18 row_newbcast:5 row_mask:0xf bank_mask:0xf
    v_and_b32_dpp v27, v4, v19 row_newbcast:5 row_mask:0xf bank_mask:0xf
    s_nop 1
    v_mfma_f32_16x16x32_bf16 v[8:11], v[24:27], v[68:71], v[8:11]
    s_waitcnt vmcnt(3)
    s_add_u32 s35, s69, 4096
    buffer_load_dwordx4 v[68:71], v1, s[44:47], s35 offen offset:1024 nt
    v_and_b32_dpp v20, v4, v16 row_newbcast:6 row_mask:0xf bank_mask:0xf
    v_and_b32_dpp v21, v4, v17 row_newbcast:6 row_mask:0xf bank_mask:0xf
    v_and_b32_dpp v22, v4, v18 row_newbcast:6 row_mask:0xf bank_mask:0xf
    v_and_b32_dpp v23, v4, v19 row_newbcast:6 row_mask:0xf bank_mask:0xf
    s_nop 1
    v_mfma_f32_16x16x32_bf16 v[8:11], v[20:23], v[72:75], v[8:11]
    s_waitcnt vmcnt(3)
    s_add_u32 s35, s69, 4096
    buffer_load_dwordx4 v[72:75], v1, s[44:47], s35 offen offset:2048 nt
    v_and_b32_dpp v24, v4, v16 row_newbcast:7 row_mask:0xf bank_mask:0xf
    v_and_b32_dpp v25, v4, v17 row_newbcast:7 row_mask:0xf bank_mask:0xf
    v_and_b32_dpp v26, v4, v18 row_newbcast:7 row_mask:0xf bank_mask:0xf
    v_and_b32_dpp v27, v4, v19 row_newbcast:7 row_mask:0xf bank_mask:0xf
    s_nop 1
    v_mfma_f32_16x16x32_bf16 v[8:11], v[24:27], v[76:79], v[8:11]
    s_waitcnt vmcnt(3)
    s_add_u32 s35, s69, 4096
    buffer_load_dwordx4 v[76:79], v1, s[44:47], s35 offen offset:3072 nt
    v_and_b32_dpp v20, v4, v16 row_newbcast:8 row_mask:0xf bank_mask:0xf
    v_and_b32_dpp v21, v4, v17 row_newbcast:8 row_mask:0xf bank_mask:0xf
    v_and_b32_dpp v22, v4, v18 row_newbcast:8 row_mask:0xf bank_mask:0xf
    v_and_b32_dpp v23, v4, v19 row_newbcast:8 row_mask:0xf bank_mask:0xf
    s_nop 1
    v_mfma_f32_16x16x32_bf16 v[8:11], v[20:23], v[80:83], v[8:11]
    s_waitcnt vmcnt(3)
    s_add_u32 s35, s69, 32768
    buffer_load_dwordx4 v[80:83], v1, s[44:47], s35 offen offset:0 nt
    v_and_b32_dpp v24, v4, v16 row_newbcast:9 row_mask:0xf bank_mask:0xf
    v_and_b32_dpp v25, v4, v17 row_newbcast:9 row_mask:0xf bank_mask:0xf
    v_and_b32_dpp v26, v4, v18 row_newbcast:9 row_mask:0xf bank_mask:0xf
    v_and_b32_dpp v27, v4, v19 row_newbcast:9 row_mask:0xf bank_mask:0xf
    s_nop 1
    v_mfma_f32_16x16x32_bf16 v[8:11], v[24:27], v[84:87], v[8:11]
    s_waitcnt vmcnt(3)
    s_add_u32 s35, s69, 32768
    buffer_load_dwordx4 v[84:87], v1, s[44:47], s35 offen offset:1024 nt
    v_and_b32_dpp v20, v4, v16 row_newbcast:10 row_mask:0xf bank_mask:0xf
    v_and_b32_dpp v21, v4, v17 row_newbcast:10 row_mask:0xf bank_mask:0xf
    v_and_b32_dpp v22, v4, v18 row_newbcast:10 row_mask:0xf bank_mask:0xf
    v_and_b32_dpp v23, v4, v19 row_newbcast:10 row_mask:0xf bank_mask:0xf
    s_nop 1
    v_mfma_f32_16x16x32_bf16 v[8:11], v[20:23], v[88:91], v[8:11]
    s_waitcnt vmcnt(3)
    s_add_u32 s35, s69, 32768
    buffer_load_dwordx4 v[88:91], v1, s[44:47], s35 offen offset:2048 nt
    v_and_b32_dpp v24, v4, v16 row_newbcast:11 row_mask:0xf bank_mask:0xf
    v_and_b32_dpp v25, v4, v17 row_newbcast:11 row_mask:0xf bank_mask:0xf
    v_and_b32_dpp v26, v4, v18 row_newbcast:11 row_mask:0xf bank_mask:0xf
    v_and_b32_dpp v27, v4, v19 row_newbcast:11 row_mask:0xf bank_mask:0xf
    s_nop 1
    v_mfma_f32_16x16x32_bf16 v[8:11], v[24:27], v[92:95], v[8:11]
    s_waitcnt vmcnt(3)
    s_add_u32 s35, s69, 32768
    buffer_load_dwordx4 v[92:95], v1, s[44:47], s35 offen offset:3072 nt
    v_and_b32_dpp v20, v4, v16 row_newbcast:12 row_mask:0xf bank_mask:0xf
    v_and_b32_dpp v21, v4, v17 row_newbcast:12 row_mask:0xf bank_mask:0xf
    v_and_b32_dpp v22, v4, v18 row_newbcast:12 row_mask:0xf bank_mask:0xf
    v_and_b32_dpp v23, v4, v19 row_newbcast:12 row_mask:0xf bank_mask:0xf
    s_nop 1
    v_mfma_f32_16x16x32_bf16 v[8:11], v[20:23], v[96:99], v[8:11]
    s_waitcnt vmcnt(3)
    s_add_u32 s35, s69, 36864
    buffer_load_dwordx4 v[96:99], v1, s[44:47], s35 offen offset:0 nt
    v_and_b32_dpp v24, v4, v16 row_newbcast:13 row_mask:0xf bank_mask:0xf
    v_and_b32_dpp v25, v4, v17 row_newbcast:13 row_mask:0xf bank_mask:0xf
    v_and_b32_dpp v26, v4, v18 row_newbcast:13 row_mask:0xf bank_mask:0xf
    v_and_b32_dpp v27, v4, v19 row_newbcast:13 row_mask:0xf bank_mask:0xf
    s_nop 1
    v_mfma_f32_16x16x32_bf16 v[8:11], v[24:27], v[100:103], v[8:11]
    s_waitcnt vmcnt(3)
    s_add_u32 s35, s69, 36864
    buffer_load_dwordx4 v[100:103], v1, s[44:47], s35 offen offset:1024 nt
    v_and_b32_dpp v20, v4, v16 row_newbcast:14 row_mask:0xf bank_mask:0xf
    v_and_b32_dpp v21, v4, v17 row_newbcast:14 row_mask:0xf bank_mask:0xf
    v_and_b32_dpp v22, v4, v18 row_newbcast:14 row_mask:0xf bank_mask:0xf
    v_and_b32_dpp v23, v4, v19 row_newbcast:14 row_mask:0xf bank_mask:0xf
    s_nop 1
    v_mfma_f32_16x16x32_bf16 v[8:11], v[20:23], v[104:107], v[8:11]
    s_waitcnt vmcnt(3)
    s_add_u32 s35, s69, 36864
    buffer_load_dwordx4 v[104:107], v1, s[44:47], s35 offen offset:2048 nt
    v_and_b32_dpp v24, v4, v16 row_newbcast:15 row_mask:0xf bank_mask:0xf
    v_and_b32_dpp v25, v4, v17 row_newbcast:15 row_mask:0xf bank_mask:0xf
    v_and_b32_dpp v26, v4, v18 row_newbcast:15 row_mask:0xf bank_mask:0xf
    v_and_b32_dpp v27, v4, v19 row_newbcast:15 row_mask:0xf bank_mask:0xf
    s_nop 1
    v_mfma_f32_16x16x32_bf16 v[8:11], v[24:27], v[108:111], v[8:11]
    s_waitcnt vmcnt(3)
    s_add_u32 s35, s69, 36864
    buffer_load_dwordx4 v[108:111], v1, s[44:47], s35 offen offset:3072 nt
    v_and_b32_dpp v20, v30, v16 row_newbcast:0 row_mask:0xf bank_mask:0xf
    v_and_b32_dpp v21, v30, v17 row_newbcast:0 row_mask:0xf bank_mask:0xf
    v_and_b32_dpp v22, v30, v18 row_newbcast:0 row_mask:0xf bank_mask:0xf
    v_and_b32_dpp v23, v30, v19 row_newbcast:0 row_mask:0xf bank_mask:0xf
    s_nop 1
    v_mfma_f32_16x16x32_bf16 v[8:11], v[20:23], v[112:115], v[8:11]
    s_waitcnt vmcnt(3)
    s_add_u32 s35, s69, 65536
    buffer_load_dwordx4 v[112:115], v1, s[44:47], s35 offen offset:0 nt
    v_and_b32_dpp v24, v30, v16 row_newbcast:1 row_mask:0xf bank_mask:0xf
    v_and_b32_dpp v25, v30, v17 row_newbcast:1 row_mask:0xf bank_mask:0xf
    v_and_b32_dpp v26, v30, v18 row_newbcast:1 row_mask:0xf bank_mask:0xf
    v_and_b32_dpp v27, v30, v19 row_newbcast:1 row_mask:0xf bank_mask:0xf
    s_nop 1
    v_mfma_f32_16x16x32_bf16 v[8:11], v[24:27], v[116:119], v[8:11]
    s_waitcnt vmcnt(3)
    s_add_u32 s35, s69, 65536
    buffer_load_dwordx4 v[116:119], v1, s[44:47], s35 offen offset:1024 nt
    v_and_b32_dpp v20, v30, v16 row_newbcast:2 row_mask:0xf bank_mask:0xf
    v_and_b32_dpp v21, v30, v17 row_newbcast:2 row_mask:0xf bank_mask:0xf
    v_and_b32_dpp v22, v30, v18 row_newbcast:2 row_mask:0xf bank_mask:0xf
    v_and_b32_dpp v23, v30, v19 row_newbcast:2 row_mask:0xf bank_mask:0xf
    s_nop 1
    v_mfma_f32_16x16x32_bf16 v[8:11], v[20:23], v[120:123], v[8:11]
    s_waitcnt vmcnt(3)
    s_add_u32 s35, s69, 65536
    buffer_load_dwordx4 v[120:123], v1, s[44:47], s35 offen offset:2048 nt
    v_and_b32_dpp v24, v30, v16 row_newbcast:3 row_mask:0xf bank_mask:0xf
    v_and_b32_dpp v25, v30, v17 row_newbcast:3 row_mask:0xf bank_mask:0xf
    v_and_b32_dpp v26, v30, v18 row_newbcast:3 row_mask:0xf bank_mask:0xf
    v_and_b32_dpp v27, v30, v19 row_newbcast:3 row_mask:0xf bank_mask:0xf
    s_nop 1
    v_mfma_f32_16x16x32_bf16 v[8:11], v[24:27], v[124:127], v[8:11]
    s_waitcnt vmcnt(3)
    s_add_u32 s35, s69, 65536
    buffer_load_dwordx4 v[124:127], v1, s[44:47], s35 offen offset:3072 nt
    v_and_b32_dpp v20, v30, v16 row_newbcast:4 row_mask:0xf bank_mask:0xf
    v_and_b32_dpp v21, v30, v17 row_newbcast:4 row_mask:0xf bank_mask:0xf
    v_and_b32_dpp v22, v30, v18 row_newbcast:4 row_mask:0xf bank_mask:0xf
    v_and_b32_dpp v23, v30, v19 row_newbcast:4 row_mask:0xf bank_mask:0xf
    s_nop 1
    v_mfma_f32_16x16x32_bf16 v[8:11], v[20:23], v[128:131], v[8:11]
    s_waitcnt vmcnt(3)
    s_add_u32 s35, s69, 69632
    buffer_load_dwordx4 v[128:131], v1, s[44:47], s35 offen offset:0 nt
    v_and_b32_dpp v24, v30, v16 row_newbcast:5 row_mask:0xf bank_mask:0xf
    v_and_b32_dpp v25, v30, v17 row_newbcast:5 row_mask:0xf bank_mask:0xf
    v_and_b32_dpp v26, v30, v18 row_newbcast:5 row_mask:0xf bank_mask:0xf
    v_and_b32_dpp v27, v30, v19 row_newbcast:5 row_mask:0xf bank_mask:0xf
    s_nop 1
    v_mfma_f32_16x16x32_bf16 v[8:11], v[24:27], v[132:135], v[8:11]
    s_waitcnt vmcnt(3)
    s_add_u32 s35, s69, 69632
    buffer_load_dwordx4 v[132:135], v1, s[44:47], s35 offen offset:1024 nt
    v_and_b32_dpp v20, v30, v16 row_newbcast:6 row_mask:0xf bank_mask:0xf
    v_and_b32_dpp v21, v30, v17 row_newbcast:6 row_mask:0xf bank_mask:0xf
    v_and_b32_dpp v22, v30, v18 row_newbcast:6 row_mask:0xf bank_mask:0xf
    v_and_b32_dpp v23, v30, v19 row_newbcast:6 row_mask:0xf bank_mask:0xf
    s_nop 1
    v_mfma_f32_16x16x32_bf16 v[8:11], v[20:23], v[136:139], v[8:11]
    s_waitcnt vmcnt(3)
    s_add_u32 s35, s69, 69632
    buffer_load_dwordx4 v[136:139], v1, s[44:47], s35 offen offset:2048 nt
    v_and_b32_dpp v24, v30, v16 row_newbcast:7 row_mask:0xf bank_mask:0xf
    v_and_b32_dpp v25, v30, v17 row_newbcast:7 row_mask:0xf bank_mask:0xf
    v_and_b32_dpp v26, v30, v18 row_newbcast:7 row_mask:0xf bank_mask:0xf
    v_and_b32_dpp v27, v30, v19 row_newbcast:7 row_mask:0xf bank_mask:0xf
    s_nop 1
    v_mfma_f32_16x16x32_bf16 v[8:11], v[24:27], v[140:143], v[8:11]
    s_waitcnt vmcnt(3)
    s_add_u32 s35, s69, 69632
    buffer_load_dwordx4 v[140:143], v1, s[44:47], s35 offen offset:3072 nt
    v_and_b32_dpp v20, v30, v16 row_newbcast:8 row_mask:0xf bank_mask:0xf
    v_and_b32_dpp v21, v30, v17 row_newbcast:8 row_mask:0xf bank_mask:0xf
    v_and_b32_dpp v22, v30, v18 row_newbcast:8 row_mask:0xf bank_mask:0xf
    v_and_b32_dpp v23, v30, v19 row_newbcast:8 row_mask:0xf bank_mask:0xf
    s_nop 1
    v_mfma_f32_16x16x32_bf16 v[8:11], v[20:23], v[144:147], v[8:11]
    s_waitcnt vmcnt(3)
    s_add_u32 s35, s69, 98304
    buffer_load_dwordx4 v[144:147], v1, s[44:47], s35 offen offset:0 nt
    v_and_b32_dpp v24, v30, v16 row_newbcast:9 row_mask:0xf bank_mask:0xf
    v_and_b32_dpp v25, v30, v17 row_newbcast:9 row_mask:0xf bank_mask:0xf
    v_and_b32_dpp v26, v30, v18 row_newbcast:9 row_mask:0xf bank_mask:0xf
    v_and_b32_dpp v27, v30, v19 row_newbcast:9 row_mask:0xf bank_mask:0xf
    s_nop 1
    v_mfma_f32_16x16x32_bf16 v[8:11], v[24:27], v[148:151], v[8:11]
    s_waitcnt vmcnt(3)
    s_add_u32 s35, s69, 98304
    buffer_load_dwordx4 v[148:151], v1, s[44:47], s35 offen offset:1024 nt
    v_and_b32_dpp v20, v30, v16 row_newbcast:10 row_mask:0xf bank_mask:0xf
    v_and_b32_dpp v21, v30, v17 row_newbcast:10 row_mask:0xf bank_mask:0xf
    v_and_b32_dpp v22, v30, v18 row_newbcast:10 row_mask:0xf bank_mask:0xf
    v_and_b32_dpp v23, v30, v19 row_newbcast:10 row_mask:0xf bank_mask:0xf
    s_nop 1
    v_mfma_f32_16x16x32_bf16 v[8:11], v[20:23], v[152:155], v[8:11]
    s_waitcnt vmcnt(3)
    s_add_u32 s35, s69, 98304
    buffer_load_dwordx4 v[152:155], v1, s[44:47], s35 offen offset:2048 nt
    v_and_b32_dpp v24, v30, v16 row_newbcast:11 row_mask:0xf bank_mask:0xf
    v_and_b32_dpp v25, v30, v17 row_newbcast:11 row_mask:0xf bank_mask:0xf
    v_and_b32_dpp v26, v30, v18 row_newbcast:11 row_mask:0xf bank_mask:0xf
    v_and_b32_dpp v27, v30, v19 row_newbcast:11 row_mask:0xf bank_mask:0xf
    s_nop 1
    v_mfma_f32_16x16x32_bf16 v[8:11], v[24:27], v[156:159], v[8:11]
    s_waitcnt vmcnt(3)
    s_add_u32 s35, s69, 98304
    buffer_load_dwordx4 v[156:159], v1, s[44:47], s35 offen offset:3072 nt
    v_and_b32_dpp v20, v30, v16 row_newbcast:12 row_mask:0xf bank_mask:0xf
    v_and_b32_dpp v21, v30, v17 row_newbcast:12 row_mask:0xf bank_mask:0xf
    v_and_b32_dpp v22, v30, v18 row_newbcast:12 row_mask:0xf bank_mask:0xf
    v_and_b32_dpp v23, v30, v19 row_newbcast:12 row_mask:0xf bank_mask:0xf
    s_nop 1
    v_mfma_f32_16x16x32_bf16 v[8:11], v[20:23], v[160:163], v[8:11]
    s_waitcnt vmcnt(3)
    s_add_u32 s35, s69, 102400
    buffer_load_dwordx4 v[160:163], v1, s[44:47], s35 offen offset:0 nt
    v_and_b32_dpp v24, v30, v16 row_newbcast:13 row_mask:0xf bank_mask:0xf
    v_and_b32_dpp v25, v30, v17 row_newbcast:13 row_mask:0xf bank_mask:0xf
    v_and_b32_dpp v26, v30, v18 row_newbcast:13 row_mask:0xf bank_mask:0xf
    v_and_b32_dpp v27, v30, v19 row_newbcast:13 row_mask:0xf bank_mask:0xf
    s_nop 1
    v_mfma_f32_16x16x32_bf16 v[8:11], v[24:27], v[164:167], v[8:11]
    s_waitcnt vmcnt(3)
    s_add_u32 s35, s69, 102400
    buffer_load_dwordx4 v[164:167], v1, s[44:47], s35 offen offset:1024 nt
    v_and_b32_dpp v20, v30, v16 row_newbcast:14 row_mask:0xf bank_mask:0xf
    v_and_b32_dpp v21, v30, v17 row_newbcast:14 row_mask:0xf bank_mask:0xf
    v_and_b32_dpp v22, v30, v18 row_newbcast:14 row_mask:0xf bank_mask:0xf
    v_and_b32_dpp v23, v30, v19 row_newbcast:14 row_mask:0xf bank_mask:0xf
    s_nop 1
    v_mfma_f32_16x16x32_bf16 v[8:11], v[20:23], v[168:171], v[8:11]
    s_waitcnt vmcnt(3)
    s_add_u32 s35, s69, 102400
    buffer_load_dwordx4 v[168:171], v1, s[44:47], s35 offen offset:2048 nt
    v_and_b32_dpp v24, v30, v16 row_newbcast:15 row_mask:0xf bank_mask:0xf
    v_and_b32_dpp v25, v30, v17 row_newbcast:15 row_mask:0xf bank_mask:0xf
    v_and_b32_dpp v26, v30, v18 row_newbcast:15 row_mask:0xf bank_mask:0xf
    v_and_b32_dpp v27, v30, v19 row_newbcast:15 row_mask:0xf bank_mask:0xf
    s_nop 1
    v_mfma_f32_16x16x32_bf16 v[8:11], v[24:27], v[172:175], v[8:11]
    s_waitcnt vmcnt(3)
    s_add_u32 s35, s69, 102400
    buffer_load_dwordx4 v[172:175], v1, s[44:47], s35 offen offset:3072 nt
    s_add_u32 s69, s69, 131072
    s_sub_u32 s10, s10, 1
    s_cmp_lg_u32 s10, 0
    s_cbranch_scc1 L_vlooplo
L_vskiplo:
    s_cmp_eq_u32 s11, 0
    s_cbranch_scc1 L_vskipmid
L_vloopmid:
    s_nop 1
    s_sub_u32 s13, s13, 1
    s_cmp_lg_u32 s13, 0
    s_cbranch_scc1 L_npmid
    v_mov_b32 v5, 98588
    v_mov_b32 v6, 1
    ds_write_b32 v5, v6
L_npmid:
    s_waitcnt lgkmcnt(0)
    v_sub_f32 v28, v28, v2
    v_mul_f32 v28, s68, v28
    v_exp_f32 v28, v28
    s_nop 0
    v_mul_f32 v28, v28, v3
    v_cvt_pk_bf16_f32 v4, v28, v28
    v_sub_f32 v183, v183, v2
    v_mul_f32 v183, s68, v183
    v_exp_f32 v183, v183
    s_nop 0
    v_mul_f32 v183, v183, v3
    v_cvt_pk_bf16_f32 v30, v183, v183
    v_add_u32 v182, 512, v182
    ds_read_b32 v28, v182
    ds_read_b32 v183, v182 offset:256
    v_and_b32_dpp v20, v4, v16 row_newbcast:0 row_mask:0xf bank_mask:0xf
    v_and_b32_dpp v21, v4, v17 row_newbcast:0 row_mask:0xf bank_mask:0xf
    v_and_b32_dpp v22, v4, v18 row_newbcast:0 row_mask:0xf bank_mask:0xf
    v_and_b32_dpp v23, v4, v19 row_newbcast:0 row_mask:0xf bank_mask:0xf
    s_nop 1
    v_mfma_f32_16x16x32_bf16 v[8:11], v[20:23], v[48:51], v[8:11]
    s_waitcnt vmcnt(4)
    buffer_load_dwordx4 v[48:51], v1, s[44:47], s69 offen offset:0 nt
    v_and_b32_dpp v24, v4, v16 row_newbcast:1 row_mask:0xf bank_mask:0xf
    v_and_b32_dpp v25, v4, v17 row_newbcast:1 row_mask:0xf bank_mask:0xf
    v_and_b32_dpp v26, v4, v18 row_newbcast:1 row_mask:0xf bank_mask:0xf
    v_and_b32_dpp v27, v4, v19 row_newbcast:1 row_mask:0xf bank_mask:0xf
    s_nop 1
    v_mfma_f32_16x16x32_bf16 v[8:11], v[24:27], v[52:55], v[8:11]
    s_waitcnt vmcnt(4)
    buffer_load_dwordx4 v[52:55], v1, s[44:47], s69 offen offset:1024 nt
    v_and_b32_dpp v20, v4, v16 row_newbcast:2 row_mask:0xf bank_mask:0xf
    v_and_b32_dpp v21, v4, v17 row_newbcast:2 row_mask:0xf bank_mask:0xf
    v_and_b32_dpp v22, v4, v18 row_newbcast:2 row_mask:0xf bank_mask:0xf
    v_and_b32_dpp v23, v4, v19 row_newbcast:2 row_mask:0xf bank_mask:0xf
    s_nop 1
    v_mfma_f32_16x16x32_bf16 v[8:11], v[20:23], v[56:59], v[8:11]
    s_waitcnt vmcnt(4)
    buffer_load_dwordx4 v[56:59], v1, s[44:47], s69 offen offset:2048 nt
    v_and_b32_dpp v24, v4, v16 row_newbcast:3 row_mask:0xf bank_mask:0xf
    v_and_b32_dpp v25, v4, v17 row_newbcast:3 row_mask:0xf bank_mask:0xf
    v_and_b32_dpp v26, v4, v18 row_newbcast:3 row_mask:0xf bank_mask:0xf
    v_and_b32_dpp v27, v4, v19 row_newbcast:3 row_mask:0xf bank_mask:0xf
    s_nop 1
    v_mfma_f32_16x16x32_bf16 v[8:11], v[24:27], v[60:63], v[8:11]
    s_waitcnt vmcnt(4)
    buffer_load_dwordx4 v[60:63], v1, s[44:47], s69 offen offset:3072 nt
    v_and_b32_dpp v20, v4, v16 row_newbcast:4 row_mask:0xf bank_mask:0xf
    v_and_b32_dpp v21, v4, v17 row_newbcast:4 row_mask:0xf bank_mask:0xf
    v_and_b32_dpp v22, v4, v18 row_newbcast:4 row_mask:0xf bank_mask:0xf
    v_and_b32_dpp v23, v4, v19 row_newbcast:4 row_mask:0xf bank_mask:0xf
    s_nop 1
    v_mfma_f32_16x16x32_bf16 v[8:11], v[20:23], v[64:67], v[8:11]
    s_waitcnt vmcnt(4)
    s_add_u32 s35, s69, 4096
    buffer_load_dwordx4 v[64:67], v1, s[44:47], s35 offen offset:0 nt
    v_and_b32_dpp v24, v4, v16 row_newbcast:5 row_mask:0xf bank_mask:0xf
    v_and_b32_dpp v25, v4, v17 row_newbcast:5 row_mask:0xf bank_mask:0xf
    v_and_b32_dpp v26, v4, v18 row_newbcast:5 row_mask:0xf bank_mask:0xf
    v_and_b32_dpp v27, v4, v19 row_newbcast:5 row_mask:0xf bank_mask:0xf
    s_nop 1
    v_mfma_f32_16x16x32_bf16 v[8:11], v[24:27], v[68:71], v[8:11]
    s_waitcnt vmcnt(4)
    s_add_u32 s35, s69, 4096
    buffer_load_dwordx4 v[68:71], v1, s[44:47], s35 offen offset:1024 nt
    v_and_b32_dpp v20, v4, v16 row_newbcast:6 row_mask:0xf bank_mask:0xf
    v_and_b32_dpp v21, v4, v17 row_newbcast:6 row_mask:0xf bank_mask:0xf
    v_and_b32_dpp v22, v4, v18 row_newbcast:6 row_mask:0xf bank_mask:0xf
    v_and_b32_dpp v23, v4, v19 row_newbcast:6 row_mask:0xf bank_mask:0xf
    s_nop 1
    v_mfma_f32_16x16x32_bf16 v[8:11], v[20:23], v[72:75], v[8:11]
    s_waitcnt vmcnt(4)
    s_add_u32 s35, s69, 4096
    buffer_load_dwordx4 v[72:75], v1, s[44:47], s35 offen offset:2048 nt
    v_and_b32_dpp v24, v4, v16 row_newbcast:7 row_mask:0xf bank_mask:0xf
    v_and_b32_dpp v25, v4, v17 row_newbcast:7 row_mask:0xf bank_mask:0xf
    v_and_b32_dpp v26, v4, v18 row_newbcast:7 row_mask:0xf bank_mask:0xf
    v_and_b32_dpp v27, v4, v19 row_newbcast:7 row_mask:0xf bank_mask:0xf
    s_nop 1
    v_mfma_f32_16x16x32_bf16 v[8:11], v[24:27], v[76:79], v[8:11]
    s_waitcnt vmcnt(4)
    s_add_u32 s35, s69, 4096
    buffer_load_dwordx4 v[76:79], v1, s[44:47], s35 offen offset:3072 nt
    v_and_b32_dpp v20, v4, v16 row_newbcast:8 row_mask:0xf bank_mask:0xf
    v_and_b32_dpp v21, v4, v17 row_newbcast:8 row_mask:0xf bank_mask:0xf
    v_and_b32_dpp v22, v4, v18 row_newbcast:8 row_mask:0xf bank_mask:0xf
    v_and_b32_dpp v23, v4, v19 row_newbcast:8 row_mask:0xf bank_mask:0xf
    s_nop 1
    v_mfma_f32_16x16x32_bf16 v[8:11], v[20:23], v[80:83], v[8:11]
    s_waitcnt vmcnt(4)
    s_add_u32 s35, s69, 32768
    buffer_load_dwordx4 v[80:83], v1, s[44:47], s35 offen offset:0 nt
    v_and_b32_dpp v24, v4, v16 row_newbcast:9 row_mask:0xf bank_mask:0xf
    v_and_b32_dpp v25, v4, v17 row_newbcast:9 row_mask:0xf bank_mask:0xf
    v_and_b32_dpp v26, v4, v18 row_newbcast:9 row_mask:0xf bank_mask:0xf
    v_and_b32_dpp v27, v4, v19 row_newbcast:9 row_mask:0xf bank_mask:0xf
    s_nop 1
    v_mfma_f32_16x16x32_bf16 v[8:11], v[24:27], v[84:87], v[8:11]
    s_waitcnt vmcnt(4)
    s_add_u32 s35, s69, 32768
    buffer_load_dwordx4 v[84:87], v1, s[44:47], s35 offen offset:1024 nt
    v_and_b32_dpp v20, v4, v16 row_newbcast:10 row_mask:0xf bank_mask:0xf
    v_and_b32_dpp v21, v4, v17 row_newbcast:10 row_mask:0xf bank_mask:0xf
    v_and_b32_dpp v22, v4, v18 row_newbcast:10 row_mask:0xf bank_mask:0xf
    v_and_b32_dpp v23, v4, v19 row_newbcast:10 row_mask:0xf bank_mask:0xf
    s_nop 1
    v_mfma_f32_16x16x32_bf16 v[8:11], v[20:23], v[88:91], v[8:11]
    s_waitcnt vmcnt(4)
    s_add_u32 s35, s69, 32768
    buffer_load_dwordx4 v[88:91], v1, s[44:47], s35 offen offset:2048 nt
    v_and_b32_dpp v24, v4, v16 row_newbcast:11 row_mask:0xf bank_mask:0xf
    v_and_b32_dpp v25, v4, v17 row_newbcast:11 row_mask:0xf bank_mask:0xf
    v_and_b32_dpp v26, v4, v18 row_newbcast:11 row_mask:0xf bank_mask:0xf
    v_and_b32_dpp v27, v4, v19 row_newbcast:11 row_mask:0xf bank_mask:0xf
    s_nop 1
    v_mfma_f32_16x16x32_bf16 v[8:11], v[24:27], v[92:95], v[8:11]
    s_waitcnt vmcnt(4)
    s_add_u32 s35, s69, 32768
    buffer_load_dwordx4 v[92:95], v1, s[44:47], s35 offen offset:3072 nt
    v_and_b32_dpp v20, v4, v16 row_newbcast:12 row_mask:0xf bank_mask:0xf
    v_and_b32_dpp v21, v4, v17 row_newbcast:12 row_mask:0xf bank_mask:0xf
    v_and_b32_dpp v22, v4, v18 row_newbcast:12 row_mask:0xf bank_mask:0xf
    v_and_b32_dpp v23, v4, v19 row_newbcast:12 row_mask:0xf bank_mask:0xf
    s_nop 1
    v_mfma_f32_16x16x32_bf16 v[8:11], v[20:23], v[96:99], v[8:11]
    s_waitcnt vmcnt(4)
    s_add_u32 s35, s69, 36864
    buffer_load_dwordx4 v[96:99], v1, s[44:47], s35 offen offset:0 nt
    v_and_b32_dpp v24, v4, v16 row_newbcast:13 row_mask:0xf bank_mask:0xf
    v_and_b32_dpp v25, v4, v17 row_newbcast:13 row_mask:0xf bank_mask:0xf
    v_and_b32_dpp v26, v4, v18 row_newbcast:13 row_mask:0xf bank_mask:0xf
    v_and_b32_dpp v27, v4, v19 row_newbcast:13 row_mask:0xf bank_mask:0xf
    s_nop 1
    v_mfma_f32_16x16x32_bf16 v[8:11], v[24:27], v[100:103], v[8:11]
    s_waitcnt vmcnt(4)
    s_add_u32 s35, s69, 36864
    buffer_load_dwordx4 v[100:103], v1, s[44:47], s35 offen offset:1024 nt
    v_and_b32_dpp v20, v4, v16 row_newbcast:14 row_mask:0xf bank_mask:0xf
    v_and_b32_dpp v21, v4, v17 row_newbcast:14 row_mask:0xf bank_mask:0xf
    v_and_b32_dpp v22, v4, v18 row_newbcast:14 row_mask:0xf bank_mask:0xf
    v_and_b32_dpp v23, v4, v19 row_newbcast:14 row_mask:0xf bank_mask:0xf
    s_nop 1
    v_mfma_f32_16x16x32_bf16 v[8:11], v[20:23], v[104:107], v[8:11]
    s_waitcnt vmcnt(4)
    s_add_u32 s35, s69, 36864
    buffer_load_dwordx4 v[104:107], v1, s[44:47], s35 offen offset:2048 nt
    v_and_b32_dpp v24, v4, v16 row_newbcast:15 row_mask:0xf bank_mask:0xf
    v_and_b32_dpp v25, v4, v17 row_newbcast:15 row_mask:0xf bank_mask:0xf
    v_and_b32_dpp v26, v4, v18 row_newbcast:15 row_mask:0xf bank_mask:0xf
    v_and_b32_dpp v27, v4, v19 row_newbcast:15 row_mask:0xf bank_mask:0xf
    s_nop 1
    v_mfma_f32_16x16x32_bf16 v[8:11], v[24:27], v[108:111], v[8:11]
    s_waitcnt vmcnt(4)
    s_add_u32 s35, s69, 36864
    buffer_load_dwordx4 v[108:111], v1, s[44:47], s35 offen offset:3072 nt
    v_and_b32_dpp v20, v30, v16 row_newbcast:0 row_mask:0xf bank_mask:0xf
    v_and_b32_dpp v21, v30, v17 row_newbcast:0 row_mask:0xf bank_mask:0xf
    v_and_b32_dpp v22, v30, v18 row_newbcast:0 row_mask:0xf bank_mask:0xf
    v_and_b32_dpp v23, v30, v19 row_newbcast:0 row_mask:0xf bank_mask:0xf
    s_nop 1
    v_mfma_f32_16x16x32_bf16 v[8:11], v[20:23], v[112:115], v[8:11]
    s_waitcnt vmcnt(4)
    s_add_u32 s35, s69, 65536
    buffer_load_dwordx4 v[112:115], v1, s[44:47], s35 offen offset:0 nt
    v_and_b32_dpp v24, v30, v16 row_newbcast:1 row_mask:0xf bank_mask:0xf
    v_and_b32_dpp v25, v30, v17 row_newbcast:1 row_mask:0xf bank_mask:0xf
    v_and_b32_dpp v26, v30, v18 row_newbcast:1 row_mask:0xf bank_mask:0xf
    v_and_b32_dpp v27, v30, v19 row_newbcast:1 row_mask:0xf bank_mask:0xf
    s_nop 1
    v_mfma_f32_16x16x32_bf16 v[8:11], v[24:27], v[116:119], v[8:11]
    s_waitcnt vmcnt(4)
    s_add_u32 s35, s69, 65536
    buffer_load_dwordx4 v[116:119], v1, s[44:47], s35 offen offset:1024 nt
    v_and_b32_dpp v20, v30, v16 row_newbcast:2 row_mask:0xf bank_mask:0xf
    v_and_b32_dpp v21, v30, v17 row_newbcast:2 row_mask:0xf bank_mask:0xf
    v_and_b32_dpp v22, v30, v18 row_newbcast:2 row_mask:0xf bank_mask:0xf
    v_and_b32_dpp v23, v30, v19 row_newbcast:2 row_mask:0xf bank_mask:0xf
    s_nop 1
    v_mfma_f32_16x16x32_bf16 v[8:11], v[20:23], v[120:123], v[8:11]
    s_waitcnt vmcnt(4)
    s_add_u32 s35, s69, 65536
    buffer_load_dwordx4 v[120:123], v1, s[44:47], s35 offen offset:2048 nt
    v_and_b32_dpp v24, v30, v16 row_newbcast:3 row_mask:0xf bank_mask:0xf
    v_and_b32_dpp v25, v30, v17 row_newbcast:3 row_mask:0xf bank_mask:0xf
    v_and_b32_dpp v26, v30, v18 row_newbcast:3 row_mask:0xf bank_mask:0xf
    v_and_b32_dpp v27, v30, v19 row_newbcast:3 row_mask:0xf bank_mask:0xf
    s_nop 1
    v_mfma_f32_16x16x32_bf16 v[8:11], v[24:27], v[124:127], v[8:11]
    s_waitcnt vmcnt(4)
    s_add_u32 s35, s69, 65536
    buffer_load_dwordx4 v[124:127], v1, s[44:47], s35 offen offset:3072 nt
    v_and_b32_dpp v20, v30, v16 row_newbcast:4 row_mask:0xf bank_mask:0xf
    v_and_b32_dpp v21, v30, v17 row_newbcast:4 row_mask:0xf bank_mask:0xf
    v_and_b32_dpp v22, v30, v18 row_newbcast:4 row_mask:0xf bank_mask:0xf
    v_and_b32_dpp v23, v30, v19 row_newbcast:4 row_mask:0xf bank_mask:0xf
    s_nop 1
    v_mfma_f32_16x16x32_bf16 v[8:11], v[20:23], v[128:131], v[8:11]
    s_waitcnt vmcnt(4)
    s_add_u32 s35, s69, 69632
    buffer_load_dwordx4 v[128:131], v1, s[44:47], s35 offen offset:0 nt
    v_and_b32_dpp v24, v30, v16 row_newbcast:5 row_mask:0xf bank_mask:0xf
    v_and_b32_dpp v25, v30, v17 row_newbcast:5 row_mask:0xf bank_mask:0xf
    v_and_b32_dpp v26, v30, v18 row_newbcast:5 row_mask:0xf bank_mask:0xf
    v_and_b32_dpp v27, v30, v19 row_newbcast:5 row_mask:0xf bank_mask:0xf
    s_nop 1
    v_mfma_f32_16x16x32_bf16 v[8:11], v[24:27], v[132:135], v[8:11]
    s_waitcnt vmcnt(4)
    s_add_u32 s35, s69, 69632
    buffer_load_dwordx4 v[132:135], v1, s[44:47], s35 offen offset:1024 nt
    v_and_b32_dpp v20, v30, v16 row_newbcast:6 row_mask:0xf bank_mask:0xf
    v_and_b32_dpp v21, v30, v17 row_newbcast:6 row_mask:0xf bank_mask:0xf
    v_and_b32_dpp v22, v30, v18 row_newbcast:6 row_mask:0xf bank_mask:0xf
    v_and_b32_dpp v23, v30, v19 row_newbcast:6 row_mask:0xf bank_mask:0xf
    s_nop 1
    v_mfma_f32_16x16x32_bf16 v[8:11], v[20:23], v[136:139], v[8:11]
    s_waitcnt vmcnt(4)
    s_add_u32 s35, s69, 69632
    buffer_load_dwordx4 v[136:139], v1, s[44:47], s35 offen offset:2048 nt
    v_and_b32_dpp v24, v30, v16 row_newbcast:7 row_mask:0xf bank_mask:0xf
    v_and_b32_dpp v25, v30, v17 row_newbcast:7 row_mask:0xf bank_mask:0xf
    v_and_b32_dpp v26, v30, v18 row_newbcast:7 row_mask:0xf bank_mask:0xf
    v_and_b32_dpp v27, v30, v19 row_newbcast:7 row_mask:0xf bank_mask:0xf
    s_nop 1
    v_mfma_f32_16x16x32_bf16 v[8:11], v[24:27], v[140:143], v[8:11]
    s_waitcnt vmcnt(4)
    s_add_u32 s35, s69, 69632
    buffer_load_dwordx4 v[140:143], v1, s[44:47], s35 offen offset:3072 nt
    v_and_b32_dpp v20, v30, v16 row_newbcast:8 row_mask:0xf bank_mask:0xf
    v_and_b32_dpp v21, v30, v17 row_newbcast:8 row_mask:0xf bank_mask:0xf
    v_and_b32_dpp v22, v30, v18 row_newbcast:8 row_mask:0xf bank_mask:0xf
    v_and_b32_dpp v23, v30, v19 row_newbcast:8 row_mask:0xf bank_mask:0xf
    s_nop 1
    v_mfma_f32_16x16x32_bf16 v[8:11], v[20:23], v[144:147], v[8:11]
    s_waitcnt vmcnt(4)
    s_add_u32 s35, s69, 98304
    buffer_load_dwordx4 v[144:147], v1, s[44:47], s35 offen offset:0 nt
    v_and_b32_dpp v24, v30, v16 row_newbcast:9 row_mask:0xf bank_mask:0xf
    v_and_b32_dpp v25, v30, v17 row_newbcast:9 row_mask:0xf bank_mask:0xf
    v_and_b32_dpp v26, v30, v18 row_newbcast:9 row_mask:0xf bank_mask:0xf
    v_and_b32_dpp v27, v30, v19 row_newbcast:9 row_mask:0xf bank_mask:0xf
    s_nop 1
    v_mfma_f32_16x16x32_bf16 v[8:11], v[24:27], v[148:151], v[8:11]
    s_waitcnt vmcnt(4)
    s_add_u32 s35, s69, 98304
    buffer_load_dwordx4 v[148:151], v1, s[44:47], s35 offen offset:1024 nt
    v_and_b32_dpp v20, v30, v16 row_newbcast:10 row_mask:0xf bank_mask:0xf
    v_and_b32_dpp v21, v30, v17 row_newbcast:10 row_mask:0xf bank_mask:0xf
    v_and_b32_dpp v22, v30, v18 row_newbcast:10 row_mask:0xf bank_mask:0xf
    v_and_b32_dpp v23, v30, v19 row_newbcast:10 row_mask:0xf bank_mask:0xf
    s_nop 1
    v_mfma_f32_16x16x32_bf16 v[8:11], v[20:23], v[152:155], v[8:11]
    s_waitcnt vmcnt(4)
    s_add_u32 s35, s69, 98304
    buffer_load_dwordx4 v[152:155], v1, s[44:47], s35 offen offset:2048 nt
    v_and_b32_dpp v24, v30, v16 row_newbcast:11 row_mask:0xf bank_mask:0xf
    v_and_b32_dpp v25, v30, v17 row_newbcast:11 row_mask:0xf bank_mask:0xf
    v_and_b32_dpp v26, v30, v18 row_newbcast:11 row_mask:0xf bank_mask:0xf
    v_and_b32_dpp v27, v30, v19 row_newbcast:11 row_mask:0xf bank_mask:0xf
    s_nop 1
    v_mfma_f32_16x16x32_bf16 v[8:11], v[24:27], v[156:159], v[8:11]
    s_waitcnt vmcnt(4)
    s_add_u32 s35, s69, 98304
    buffer_load_dwordx4 v[156:159], v1, s[44:47], s35 offen offset:3072 nt
    v_and_b32_dpp v20, v30, v16 row_newbcast:12 row_mask:0xf bank_mask:0xf
    v_and_b32_dpp v21, v30, v17 row_newbcast:12 row_mask:0xf bank_mask:0xf
    v_and_b32_dpp v22, v30, v18 row_newbcast:12 row_mask:0xf bank_mask:0xf
    v_and_b32_dpp v23, v30, v19 row_newbcast:12 row_mask:0xf bank_mask:0xf
    s_nop 1
    v_mfma_f32_16x16x32_bf16 v[8:11], v[20:23], v[160:163], v[8:11]
    s_waitcnt vmcnt(4)
    s_add_u32 s35, s69, 102400
    buffer_load_dwordx4 v[160:163], v1, s[44:47], s35 offen offset:0 nt
    v_and_b32_dpp v24, v30, v16 row_newbcast:13 row_mask:0xf bank_mask:0xf
    v_and_b32_dpp v25, v30, v17 row_newbcast:13 row_mask:0xf bank_mask:0xf
    v_and_b32_dpp v26, v30, v18 row_newbcast:13 row_mask:0xf bank_mask:0xf
    v_and_b32_dpp v27, v30, v19 row_newbcast:13 row_mask:0xf bank_mask:0xf
    s_nop 1
    v_mfma_f32_16x16x32_bf16 v[8:11], v[24:27], v[164:167], v[8:11]
    s_waitcnt vmcnt(4)
    s_add_u32 s35, s69, 102400
    buffer_load_dwordx4 v[164:167], v1, s[44:47], s35 offen offset:1024 nt
    v_and_b32_dpp v20, v30, v16 row_newbcast:14 row_mask:0xf bank_mask:0xf
    v_and_b32_dpp v21, v30, v17 row_newbcast:14 row_mask:0xf bank_mask:0xf
    v_and_b32_dpp v22, v30, v18 row_newbcast:14 row_mask:0xf bank_mask:0xf
    v_and_b32_dpp v23, v30, v19 row_newbcast:14 row_mask:0xf bank_mask:0xf
    s_nop 1
    v_mfma_f32_16x16x32_bf16 v[8:11], v[20:23], v[168:171], v[8:11]
    s_waitcnt vmcnt(4)
    s_add_u32 s35, s69, 102400
    buffer_load_dwordx4 v[168:171], v1, s[44:47], s35 offen offset:2048 nt
    v_and_b32_dpp v24, v30, v16 row_newbcast:15 row_mask:0xf bank_mask:0xf
    v_and_b32_dpp v25, v30, v17 row_newbcast:15 row_mask:0xf bank_mask:0xf
    v_and_b32_dpp v26, v30, v18 row_newbcast:15 row_mask:0xf bank_mask:0xf
    v_and_b32_dpp v27, v30, v19 row_newbcast:15 row_mask:0xf bank_mask:0xf
    s_nop 1
    v_mfma_f32_16x16x32_bf16 v[8:11], v[24:27], v[172:175], v[8:11]
    s_waitcnt vmcnt(4)
    s_add_u32 s35, s69, 102400
    buffer_load_dwordx4 v[172:175], v1, s[44:47], s35 offen offset:3072 nt
    s_add_u32 s69, s69, 131072
    s_sub_u32 s11, s11, 1
    s_cmp_lg_u32 s11, 0
    s_cbranch_scc1 L_vloopmid
L_vskipmid:
    s_cmp_eq_u32 s14, 98584
    s_cbranch_scc1 L_stend
    s_mov_b32 s13, 2
    s_mov_b32 s14, 98584
    s_branch L_stage
L_stend:
    s_nop 1
    v_mov_b32 v5, 98568
    v_mov_b32 v6, 1
    ds_write_b32 v5, v6
    s_and_b32 s57, s2, 7
    s_lshr_b32 s58, s2, 3
    s_lshl_b32 s6, s57, 1
    s_lshr_b32 s57, s58, 4
    s_add_u32 s6, s6, s57
    s_add_u32 s7, s58, 7
    s_and_b32 s7, s7, 15
    s_lshl_b32 s70, s6, 19
    s_lshl_b32 s59, s6, 11
    s_lshl_b32 s58, s7, 7
    s_add_u32 s70, s70, s58
    s_lshl_b32 s58, s7, 15
    s_add_u32 s59, s59, s58
    s_lshl_b32 s57, s3, 17
    s_add_u32 s70, s70, s57
    s_lshl_b32 s57, s3, 6
    s_add_u32 s59, s59, s57
    s_add_u32 s59, s59, 4194304
    s_lshl_b32 s58, s3, 13
    s_add_u32 m0, s58, 0
    s_add_u32 s57, s70, 0
    buffer_load_dwordx4 v176, s[48:51], s57 offen nt lds
    s_add_u32 m0, s58, 1024
    s_add_u32 s57, s70, 16384
    buffer_load_dwordx4 v177, s[48:51], s57 offen nt lds
    s_add_u32 m0, s58, 2048
    s_add_u32 s57, s70, 32768
    buffer_load_dwordx4 v176, s[48:51], s57 offen nt lds
    s_add_u32 m0, s58, 3072
    s_add_u32 s57, s70, 49152
    buffer_load_dwordx4 v177, s[48:51], s57 offen nt lds
    s_add_u32 m0, s58, 4096
    s_add_u32 s57, s70, 65536
    buffer_load_dwordx4 v176, s[48:51], s57 offen nt lds
    s_add_u32 m0, s58, 5120
    s_add_u32 s57, s70, 81920
    buffer_load_dwordx4 v177, s[48:51], s57 offen nt lds
    s_add_u32 m0, s58, 6144
    s_add_u32 s57, s70, 98304
    buffer_load_dwordx4 v176, s[48:51], s57 offen nt lds
    s_add_u32 m0, s58, 7168
    s_add_u32 s57, s70, 114688
    buffer_load_dwordx4 v177, s[48:51], s57 offen nt lds
    s_waitcnt lgkmcnt(0)
    v_sub_f32 v28, v28, v2
    v_mul_f32 v28, s68, v28
    v_exp_f32 v28, v28
    s_nop 0
    v_mul_f32 v28, v28, v3
    v_cvt_pk_bf16_f32 v4, v28, v28
    v_sub_f32 v183, v183, v2
    v_mul_f32 v183, s68, v183
    v_exp_f32 v183, v183
    s_nop 0
    v_mul_f32 v183, v183, v3
    v_cvt_pk_bf16_f32 v30, v183, v183
    v_and_b32_dpp v20, v4, v16 row_newbcast:0 row_mask:0xf bank_mask:0xf
    v_and_b32_dpp v21, v4, v17 row_newbcast:0 row_mask:0xf bank_mask:0xf
    v_and_b32_dpp v22, v4, v18 row_newbcast:0 row_mask:0xf bank_mask:0xf
    v_and_b32_dpp v23, v4, v19 row_newbcast:0 row_mask:0xf bank_mask:0xf
    s_nop 1
    v_mfma_f32_16x16x32_bf16 v[8:11], v[20:23], v[48:51], v[8:11]
    v_and_b32_dpp v24, v4, v16 row_newbcast:1 row_mask:0xf bank_mask:0xf
    v_and_b32_dpp v25, v4, v17 row_newbcast:1 row_mask:0xf bank_mask:0xf
    v_and_b32_dpp v26, v4, v18 row_newbcast:1 row_mask:0xf bank_mask:0xf
    v_and_b32_dpp v27, v4, v19 row_newbcast:1 row_mask:0xf bank_mask:0xf
    s_nop 1
    v_mfma_f32_16x16x32_bf16 v[8:11], v[24:27], v[52:55], v[8:11]
    v_and_b32_dpp v20, v4, v16 row_newbcast:2 row_mask:0xf bank_mask:0xf
    v_and_b32_dpp v21, v4, v17 row_newbcast:2 row_mask:0xf bank_mask:0xf
    v_and_b32_dpp v22, v4, v18 row_newbcast:2 row_mask:0xf bank_mask:0xf
    v_and_b32_dpp v23, v4, v19 row_newbcast:2 row_mask:0xf bank_mask:0xf
    s_nop 1
    v_mfma_f32_16x16x32_bf16 v[8:11], v[20:23], v[56:59], v[8:11]
    v_and_b32_dpp v24, v4, v16 row_newbcast:3 row_mask:0xf bank_mask:0xf
    v_and_b32_dpp v25, v4, v17 row_newbcast:3 row_mask:0xf bank_mask:0xf
    v_and_b32_dpp v26, v4, v18 row_newbcast:3 row_mask:0xf bank_mask:0xf
    v_and_b32_dpp v27, v4, v19 row_newbcast:3 row_mask:0xf bank_mask:0xf
    s_nop 1
    v_mfma_f32_16x16x32_bf16 v[8:11], v[24:27], v[60:63], v[8:11]
    v_and_b32_dpp v20, v4, v16 row_newbcast:4 row_mask:0xf bank_mask:0xf
    v_and_b32_dpp v21, v4, v17 row_newbcast:4 row_mask:0xf bank_mask:0xf
    v_and_b32_dpp v22, v4, v18 row_newbcast:4 row_mask:0xf bank_mask:0xf
    v_and_b32_dpp v23, v4, v19 row_newbcast:4 row_mask:0xf bank_mask:0xf
    s_nop 1
    v_mfma_f32_16x16x32_bf16 v[8:11], v[20:23], v[64:67], v[8:11]
    v_and_b32_dpp v24, v4, v16 row_newbcast:5 row_mask:0xf bank_mask:0xf
    v_and_b32_dpp v25, v4, v17 row_newbcast:5 row_mask:0xf bank_mask:0xf
    v_and_b32_dpp v26, v4, v18 row_newbcast:5 row_mask:0xf bank_mask:0xf
    v_and_b32_dpp v27, v4, v19 row_newbcast:5 row_mask:0xf bank_mask:0xf
    s_nop 1
    v_mfma_f32_16x16x32_bf16 v[8:11], v[24:27], v[68:71], v[8:11]
    v_and_b32_dpp v20, v4, v16 row_newbcast:6 row_mask:0xf bank_mask:0xf
    v_and_b32_dpp v21, v4, v17 row_newbcast:6 row_mask:0xf bank_mask:0xf
    v_and_b32_dpp v22, v4, v18 row_newbcast:6 row_mask:0xf bank_mask:0xf
    v_and_b32_dpp v23, v4, v19 row_newbcast:6 row_mask:0xf bank_mask:0xf
    s_nop 1
    v_mfma_f32_16x16x32_bf16 v[8:11], v[20:23], v[72:75], v[8:11]
    v_and_b32_dpp v24, v4, v16 row_newbcast:7 row_mask:0xf bank_mask:0xf
    v_and_b32_dpp v25, v4, v17 row_newbcast:7 row_mask:0xf bank_mask:0xf
    v_and_b32_dpp v26, v4, v18 row_newbcast:7 row_mask:0xf bank_mask:0xf
    v_and_b32_dpp v27, v4, v19 row_newbcast:7 row_mask:0xf bank_mask:0xf
    s_nop 1
    v_mfma_f32_16x16x32_bf16 v[8:11], v[24:27], v[76:79], v[8:11]
    v_and_b32_dpp v20, v4, v16 row_newbcast:8 row_mask:0xf bank_mask:0xf
    v_and_b32_dpp v21, v4, v17 row_newbcast:8 row_mask:0xf bank_mask:0xf
    v_and_b32_dpp v22, v4, v18 row_newbcast:8 row_mask:0xf bank_mask:0xf
    v_and_b32_dpp v23, v4, v19 row_newbcast:8 row_mask:0xf bank_mask:0xf
    s_nop 1
    v_mfma_f32_16x16x32_bf16 v[8:11], v[20:23], v[80:83], v[8:11]
    v_and_b32_dpp v24, v4, v16 row_newbcast:9 row_mask:0xf bank_mask:0xf
    v_and_b32_dpp v25, v4, v17 row_newbcast:9 row_mask:0xf bank_mask:0xf
    v_and_b32_dpp v26, v4, v18 row_newbcast:9 row_mask:0xf bank_mask:0xf
    v_and_b32_dpp v27, v4, v19 row_newbcast:9 row_mask:0xf bank_mask:0xf
    s_nop 1
    v_mfma_f32_16x16x32_bf16 v[8:11], v[24:27], v[84:87], v[8:11]
    v_and_b32_dpp v20, v4, v16 row_newbcast:10 row_mask:0xf bank_mask:0xf
    v_and_b32_dpp v21, v4, v17 row_newbcast:10 row_mask:0xf bank_mask:0xf
    v_and_b32_dpp v22, v4, v18 row_newbcast:10 row_mask:0xf bank_mask:0xf
    v_and_b32_dpp v23, v4, v19 row_newbcast:10 row_mask:0xf bank_mask:0xf
    s_nop 1
    v_mfma_f32_16x16x32_bf16 v[8:11], v[20:23], v[88:91], v[8:11]
    v_and_b32_dpp v24, v4, v16 row_newbcast:11 row_mask:0xf bank_mask:0xf
    v_and_b32_dpp v25, v4, v17 row_newbcast:11 row_mask:0xf bank_mask:0xf
    v_and_b32_dpp v26, v4, v18 row_newbcast:11 row_mask:0xf bank_mask:0xf
    v_and_b32_dpp v27, v4, v19 row_newbcast:11 row_mask:0xf bank_mask:0xf
    s_nop 1
    v_mfma_f32_16x16x32_bf16 v[8:11], v[24:27], v[92:95], v[8:11]
    v_and_b32_dpp v20, v4, v16 row_newbcast:12 row_mask:0xf bank_mask:0xf
    v_and_b32_dpp v21, v4, v17 row_newbcast:12 row_mask:0xf bank_mask:0xf
    v_and_b32_dpp v22, v4, v18 row_newbcast:12 row_mask:0xf bank_mask:0xf
    v_and_b32_dpp v23, v4, v19 row_newbcast:12 row_mask:0xf bank_mask:0xf
    s_nop 1
    v_mfma_f32_16x16x32_bf16 v[8:11], v[20:23], v[96:99], v[8:11]
    v_and_b32_dpp v24, v4, v16 row_newbcast:13 row_mask:0xf bank_mask:0xf
    v_and_b32_dpp v25, v4, v17 row_newbcast:13 row_mask:0xf bank_mask:0xf
    v_and_b32_dpp v26, v4, v18 row_newbcast:13 row_mask:0xf bank_mask:0xf
    v_and_b32_dpp v27, v4, v19 row_newbcast:13 row_mask:0xf bank_mask:0xf
    s_nop 1
    v_mfma_f32_16x16x32_bf16 v[8:11], v[24:27], v[100:103], v[8:11]
    v_and_b32_dpp v20, v4, v16 row_newbcast:14 row_mask:0xf bank_mask:0xf
    v_and_b32_dpp v21, v4, v17 row_newbcast:14 row_mask:0xf bank_mask:0xf
    v_and_b32_dpp v22, v4, v18 row_newbcast:14 row_mask:0xf bank_mask:0xf
    v_and_b32_dpp v23, v4, v19 row_newbcast:14 row_mask:0xf bank_mask:0xf
    s_nop 1
    v_mfma_f32_16x16x32_bf16 v[8:11], v[20:23], v[104:107], v[8:11]
    v_and_b32_dpp v24, v4, v16 row_newbcast:15 row_mask:0xf bank_mask:0xf
    v_and_b32_dpp v25, v4, v17 row_newbcast:15 row_mask:0xf bank_mask:0xf
    v_and_b32_dpp v26, v4, v18 row_newbcast:15 row_mask:0xf bank_mask:0xf
    v_and_b32_dpp v27, v4, v19 row_newbcast:15 row_mask:0xf bank_mask:0xf
    s_nop 1
    v_mfma_f32_16x16x32_bf16 v[8:11], v[24:27], v[108:111], v[8:11]
    v_and_b32_dpp v20, v30, v16 row_newbcast:0 row_mask:0xf bank_mask:0xf
    v_and_b32_dpp v21, v30, v17 row_newbcast:0 row_mask:0xf bank_mask:0xf
    v_and_b32_dpp v22, v30, v18 row_newbcast:0 row_mask:0xf bank_mask:0xf
    v_and_b32_dpp v23, v30, v19 row_newbcast:0 row_mask:0xf bank_mask:0xf
    s_nop 1
    v_mfma_f32_16x16x32_bf16 v[8:11], v[20:23], v[112:115], v[8:11]
    v_and_b32_dpp v24, v30, v16 row_newbcast:1 row_mask:0xf bank_mask:0xf
    v_and_b32_dpp v25, v30, v17 row_newbcast:1 row_mask:0xf bank_mask:0xf
    v_and_b32_dpp v26, v30, v18 row_newbcast:1 row_mask:0xf bank_mask:0xf
    v_and_b32_dpp v27, v30, v19 row_newbcast:1 row_mask:0xf bank_mask:0xf
    s_nop 1
    v_mfma_f32_16x16x32_bf16 v[8:11], v[24:27], v[116:119], v[8:11]
    v_and_b32_dpp v20, v30, v16 row_newbcast:2 row_mask:0xf bank_mask:0xf
    v_and_b32_dpp v21, v30, v17 row_newbcast:2 row_mask:0xf bank_mask:0xf
    v_and_b32_dpp v22, v30, v18 row_newbcast:2 row_mask:0xf bank_mask:0xf
    v_and_b32_dpp v23, v30, v19 row_newbcast:2 row_mask:0xf bank_mask:0xf
    s_nop 1
    v_mfma_f32_16x16x32_bf16 v[8:11], v[20:23], v[120:123], v[8:11]
    v_and_b32_dpp v24, v30, v16 row_newbcast:3 row_mask:0xf bank_mask:0xf
    v_and_b32_dpp v25, v30, v17 row_newbcast:3 row_mask:0xf bank_mask:0xf
    v_and_b32_dpp v26, v30, v18 row_newbcast:3 row_mask:0xf bank_mask:0xf
    v_and_b32_dpp v27, v30, v19 row_newbcast:3 row_mask:0xf bank_mask:0xf
    s_nop 1
    v_mfma_f32_16x16x32_bf16 v[8:11], v[24:27], v[124:127], v[8:11]
    v_and_b32_dpp v20, v30, v16 row_newbcast:4 row_mask:0xf bank_mask:0xf
    v_and_b32_dpp v21, v30, v17 row_newbcast:4 row_mask:0xf bank_mask:0xf
    v_and_b32_dpp v22, v30, v18 row_newbcast:4 row_mask:0xf bank_mask:0xf
    v_and_b32_dpp v23, v30, v19 row_newbcast:4 row_mask:0xf bank_mask:0xf
    s_nop 1
    v_mfma_f32_16x16x32_bf16 v[8:11], v[20:23], v[128:131], v[8:11]
    v_and_b32_dpp v24, v30, v16 row_newbcast:5 row_mask:0xf bank_mask:0xf
    v_and_b32_dpp v25, v30, v17 row_newbcast:5 row_mask:0xf bank_mask:0xf
    v_and_b32_dpp v26, v30, v18 row_newbcast:5 row_mask:0xf bank_mask:0xf
    v_and_b32_dpp v27, v30, v19 row_newbcast:5 row_mask:0xf bank_mask:0xf
    s_nop 1
    v_mfma_f32_16x16x32_bf16 v[8:11], v[24:27], v[132:135], v[8:11]
    v_and_b32_dpp v20, v30, v16 row_newbcast:6 row_mask:0xf bank_mask:0xf
    v_and_b32_dpp v21, v30, v17 row_newbcast:6 row_mask:0xf bank_mask:0xf
    v_and_b32_dpp v22, v30, v18 row_newbcast:6 row_mask:0xf bank_mask:0xf
    v_and_b32_dpp v23, v30, v19 row_newbcast:6 row_mask:0xf bank_mask:0xf
    s_nop 1
    v_mfma_f32_16x16x32_bf16 v[8:11], v[20:23], v[136:139], v[8:11]
    v_and_b32_dpp v24, v30, v16 row_newbcast:7 row_mask:0xf bank_mask:0xf
    v_and_b32_dpp v25, v30, v17 row_newbcast:7 row_mask:0xf bank_mask:0xf
    v_and_b32_dpp v26, v30, v18 row_newbcast:7 row_mask:0xf bank_mask:0xf
    v_and_b32_dpp v27, v30, v19 row_newbcast:7 row_mask:0xf bank_mask:0xf
    s_nop 1
    v_mfma_f32_16x16x32_bf16 v[8:11], v[24:27], v[140:143], v[8:11]
    v_and_b32_dpp v20, v30, v16 row_newbcast:8 row_mask:0xf bank_mask:0xf
    v_and_b32_dpp v21, v30, v17 row_newbcast:8 row_mask:0xf bank_mask:0xf
    v_and_b32_dpp v22, v30, v18 row_newbcast:8 row_mask:0xf bank_mask:0xf
    v_and_b32_dpp v23, v30, v19 row_newbcast:8 row_mask:0xf bank_mask:0xf
    s_waitcnt vmcnt(15)
    s_nop 0
    v_mfma_f32_16x16x32_bf16 v[8:11], v[20:23], v[144:147], v[8:11]
    v_and_b32_dpp v24, v30, v16 row_newbcast:9 row_mask:0xf bank_mask:0xf
    v_and_b32_dpp v25, v30, v17 row_newbcast:9 row_mask:0xf bank_mask:0xf
    v_and_b32_dpp v26, v30, v18 row_newbcast:9 row_mask:0xf bank_mask:0xf
    v_and_b32_dpp v27, v30, v19 row_newbcast:9 row_mask:0xf bank_mask:0xf
    s_waitcnt vmcnt(14)
    s_nop 0
    v_mfma_f32_16x16x32_bf16 v[8:11], v[24:27], v[148:151], v[8:11]
    v_and_b32_dpp v20, v30, v16 row_newbcast:10 row_mask:0xf bank_mask:0xf
    v_and_b32_dpp v21, v30, v17 row_newbcast:10 row_mask:0xf bank_mask:0xf
    v_and_b32_dpp v22, v30, v18 row_newbcast:10 row_mask:0xf bank_mask:0xf
    v_and_b32_dpp v23, v30, v19 row_newbcast:10 row_mask:0xf bank_mask:0xf
    s_waitcnt vmcnt(13)
    s_nop 0
    v_mfma_f32_16x16x32_bf16 v[8:11], v[20:23], v[152:155], v[8:11]
    v_and_b32_dpp v24, v30, v16 row_newbcast:11 row_mask:0xf bank_mask:0xf
    v_and_b32_dpp v25, v30, v17 row_newbcast:11 row_mask:0xf bank_mask:0xf
    v_and_b32_dpp v26, v30, v18 row_newbcast:11 row_mask:0xf bank_mask:0xf
    v_and_b32_dpp v27, v30, v19 row_newbcast:11 row_mask:0xf bank_mask:0xf
    s_waitcnt vmcnt(12)
    s_nop 0
    v_mfma_f32_16x16x32_bf16 v[8:11], v[24:27], v[156:159], v[8:11]
    v_and_b32_dpp v20, v30, v16 row_newbcast:12 row_mask:0xf bank_mask:0xf
    v_and_b32_dpp v21, v30, v17 row_newbcast:12 row_mask:0xf bank_mask:0xf
    v_and_b32_dpp v22, v30, v18 row_newbcast:12 row_mask:0xf bank_mask:0xf
    v_and_b32_dpp v23, v30, v19 row_newbcast:12 row_mask:0xf bank_mask:0xf
    s_waitcnt vmcnt(11)
    s_nop 0
    v_mfma_f32_16x16x32_bf16 v[8:11], v[20:23], v[160:163], v[8:11]
    v_and_b32_dpp v24, v30, v16 row_newbcast:13 row_mask:0xf bank_mask:0xf
    v_and_b32_dpp v25, v30, v17 row_newbcast:13 row_mask:0xf bank_mask:0xf
    v_and_b32_dpp v26, v30, v18 row_newbcast:13 row_mask:0xf bank_mask:0xf
    v_and_b32_dpp v27, v30, v19 row_newbcast:13 row_mask:0xf bank_mask:0xf
    s_waitcnt vmcnt(10)
    s_nop 0
    v_mfma_f32_16x16x32_bf16 v[8:11], v[24:27], v[164:167], v[8:11]
    v_and_b32_dpp v20, v30, v16 row_newbcast:14 row_mask:0xf bank_mask:0xf
    v_and_b32_dpp v21, v30, v17 row_newbcast:14 row_mask:0xf bank_mask:0xf
    v_and_b32_dpp v22, v30, v18 row_newbcast:14 row_mask:0xf bank_mask:0xf
    v_and_b32_dpp v23, v30, v19 row_newbcast:14 row_mask:0xf bank_mask:0xf
    s_waitcnt vmcnt(9)
    s_nop 0
    v_mfma_f32_16x16x32_bf16 v[8:11], v[20:23], v[168:171], v[8:11]
    v_and_b32_dpp v24, v30, v16 row_newbcast:15 row_mask:0xf bank_mask:0xf
    v_and_b32_dpp v25, v30, v17 row_newbcast:15 row_mask:0xf bank_mask:0xf
    v_and_b32_dpp v26, v30, v18 row_newbcast:15 row_mask:0xf bank_mask:0xf
    v_and_b32_dpp v27, v30, v19 row_newbcast:15 row_mask:0xf bank_mask:0xf
    s_waitcnt vmcnt(8)
    s_nop 0
    v_mfma_f32_16x16x32_bf16 v[8:11], v[24:27], v[172:175], v[8:11]
    v_lshlrev_b32 v5, 4, v0
    s_lshl_b32 s57, s3, 9
    s_add_u32 s57, s57, 99328
    v_add_u32 v5, s57, v5
    s_mov_b32 s66, -1
    s_mov_b32 s67, 0
    s_mov_b64 exec, s[66:67]
    s_nop 0
    ds_write_b128 v5, v[8:11]
    s_mov_b64 exec, -1
    s_waitcnt lgkmcnt(0)
    s_barrier
    s_waitcnt vmcnt(0)
    v_mov_b32 v5, 98564
    v_mov_b32 v6, 1
    s_mov_b64 exec, 1
    ds_add_u32 v5, v6
    s_mov_b64 exec, -1
    v_mov_b32 v5, 98564
    s_mov_b32 s58, 3200000
L_cw:
    ds_read_b32 v6, v5
    s_waitcnt lgkmcnt(0)
    v_readfirstlane_b32 s57, v6
    s_nop 0
    s_cmp_ge_u32 s57, 4
    s_cbranch_scc1 L_ck
    s_sub_u32 s58, s58, 1
    s_cmp_eq_u32 s58, 0
    s_cbranch_scc1 L_ck
    s_branch L_cw
L_ck:
    ds_read_b64_tr_b16 v[48:49], v178 offset:0
    ds_read_b64_tr_b16 v[50:51], v178 offset:512
    ds_read_b64_tr_b16 v[52:53], v178 offset:4096
    ds_read_b64_tr_b16 v[54:55], v178 offset:4608
    ds_read_b64_tr_b16 v[56:57], v178 offset:8192
    ds_read_b64_tr_b16 v[58:59], v178 offset:8704
    ds_read_b64_tr_b16 v[60:61], v178 offset:12288
    ds_read_b64_tr_b16 v[62:63], v178 offset:12800
    s_waitcnt lgkmcnt(0)
    ds_read_b64_tr_b16 v[64:65], v178 offset:16384
    ds_read_b64_tr_b16 v[66:67], v178 offset:16896
    ds_read_b64_tr_b16 v[68:69], v178 offset:20480
    ds_read_b64_tr_b16 v[70:71], v178 offset:20992
    ds_read_b64_tr_b16 v[72:73], v178 offset:24576
    ds_read_b64_tr_b16 v[74:75], v178 offset:25088
    ds_read_b64_tr_b16 v[76:77], v178 offset:28672
    ds_read_b64_tr_b16 v[78:79], v178 offset:29184
    s_waitcnt lgkmcnt(0)
    s_barrier
    ds_read_b128 v[80:83], v179 offset:0
    ds_read_b128 v[84:87], v179 offset:64
    ds_read_b128 v[88:91], v179 offset:128
    ds_read_b128 v[92:95], v179 offset:192
    ds_read_b128 v[96:99], v179 offset:2176
    ds_read_b128 v[100:103], v179 offset:2240
    ds_read_b128 v[104:107], v179 offset:2304
    ds_read_b128 v[108:111], v179 offset:2368
    s_waitcnt lgkmcnt(7)
    v_mfma_f32_16x16x32_bf16 v[32:35], v[48:51], v[80:83], 0
    s_waitcnt lgkmcnt(6)
    v_mfma_f32_16x16x32_bf16 v[32:35], v[52:55], v[84:87], v[32:35]
    s_waitcnt lgkmcnt(5)
    v_mfma_f32_16x16x32_bf16 v[32:35], v[56:59], v[88:91], v[32:35]
    s_waitcnt lgkmcnt(4)
    v_mfma_f32_16x16x32_bf16 v[32:35], v[60:63], v[92:95], v[32:35]
    s_waitcnt lgkmcnt(3)
    v_mfma_f32_16x16x32_bf16 v[32:35], v[64:67], v[96:99], v[32:35]
    s_waitcnt lgkmcnt(2)
    v_mfma_f32_16x16x32_bf16 v[32:35], v[68:71], v[100:103], v[32:35]
    s_waitcnt lgkmcnt(1)
    v_mfma_f32_16x16x32_bf16 v[32:35], v[72:75], v[104:107], v[32:35]
    s_waitcnt lgkmcnt(0)
    v_mfma_f32_16x16x32_bf16 v[32:35], v[76:79], v[108:111], v[32:35]
    s_nop 7
    v_add_u32 v5, 0x80, v32
    v_bfi_b32 v36, v181, v5, s72
    v_add_u32 v5, 0x80, v33
    v_bfi_b32 v37, v181, v5, s73
    v_add_u32 v5, 0x80, v34
    v_bfi_b32 v38, v181, v5, s74
    v_add_u32 v5, 0x80, v35
    v_bfi_b32 v39, v181, v5, s75
    s_mov_b32 s66, 0x00ff00ff
    s_mov_b32 s67, 0x00ff00ff
    s_mov_b64 exec, s[66:67]
    buffer_store_dwordx4 v[36:39], v180, s[36:39], s59 offen sc1
    s_mov_b64 exec, -1
    s_endpgm
L_aux0:
    v_mov_b32 v1, 98560
    v_mov_b32 v4, 0
    v_mov_b32 v5, 0
    v_mov_b32 v6, 0
    v_mov_b32 v7, 0
    ds_write_b128 v1, v[4:7]
    ds_write_b128 v1, v[4:7] offset:16
    ds_write_b128 v1, v[4:7] offset:32
    s_mov_b32 s44, s14
    s_and_b32 s45, s15, 0xffff
    s_mov_b32 s46, 8388608
    s_mov_b32 s47, 0x20000
    s_mov_b32 s40, s8
    s_and_b32 s41, s9, 0xffff
    s_mov_b32 s42, 16384
    s_mov_b32 s43, 0x20000
    buffer_load_dword v182, off, s[36:39], 0 offset:0 sc1
    s_and_b32 s57, s2, 7
    s_lshr_b32 s58, s2, 3
    s_add_u32 s59, s58, 6
    s_sub_u32 s6, s59, 32
    s_cmp_ge_u32 s59, 32
    s_cselect_b32 s59, s6, s59
    s_lshr_b32 s7, s57, 1
    s_and_b32 s6, s57, 1
    s_mul_i32 s6, s6, 32
    s_add_u32 s6, s6, s59
    v_and_b32 v181, 7, v0
    v_lshlrev_b32 v181, 11, v181
    v_lshrrev_b32 v1, 4, v0
    v_lshl_add_u32 v181, v1, 4, v181
    s_lshl_b32 s57, s7, 9
    buffer_load_dwordx4 v[8:11], v181, s[40:43], s57 offen offset:0
    buffer_load_dwordx4 v[12:15], v181, s[40:43], s57 offen offset:64
    buffer_load_dwordx4 v[16:19], v181, s[40:43], s57 offen offset:128
    buffer_load_dwordx4 v[20:23], v181, s[40:43], s57 offen offset:192
    buffer_load_dwordx4 v[24:27], v181, s[40:43], s57 offen offset:256
    buffer_load_dwordx4 v[28:31], v181, s[40:43], s57 offen offset:320
    buffer_load_dwordx4 v[32:35], v181, s[40:43], s57 offen offset:384
    buffer_load_dwordx4 v[36:39], v181, s[40:43], s57 offen offset:448
    v_bfe_u32 v1, v0, 4, 1
    v_lshlrev_b32 v1, 1, v1
    v_and_b32 v2, 7, v0
    v_xor_b32 v2, v1, v2
    v_lshlrev_b32 v2, 4, v2
    v_lshrrev_b32 v1, 3, v0
    s_mov_b32 s57, 8192
    v_mul_lo_u32 v1, v1, s57
    v_add_u32 v176, v1, v2
    v_xor_b32 v2, 64, v2
    v_add_u32 v177, v1, v2
    s_mul_i32 s59, s7, 2097152
    s_lshl_b32 s57, s6, 7
    s_add_u32 s59, s59, s57
    s_lshl_b32 s69, s7, 9
    s_lshr_b32 s57, s6, 1
    s_lshl_b32 s57, s57, 14
    s_add_u32 s69, s69, s57
    s_and_b32 s57, s6, 1
    s_lshl_b32 s57, s57, 8
    s_add_u32 s69, s69, s57
    s_mov_b32 m0, 0
    s_add_u32 s57, s59, 0
    buffer_load_dwordx4 v176, s[44:47], s57 offen nt lds
    s_mov_b32 m0, 1024
    s_add_u32 s57, s59, 65536
    buffer_load_dwordx4 v177, s[44:47], s57 offen nt lds
    s_mov_b32 m0, 2048
    s_add_u32 s57, s59, 131072
    buffer_load_dwordx4 v176, s[44:47], s57 offen nt lds
    s_mov_b32 m0, 3072
    s_add_u32 s57, s59, 196608
    buffer_load_dwordx4 v177, s[44:47], s57 offen nt lds
    s_mov_b32 m0, 4096
    s_add_u32 s57, s59, 262144
    buffer_load_dwordx4 v176, s[44:47], s57 offen nt lds
    s_mov_b32 m0, 5120
    s_add_u32 s57, s59, 327680
    buffer_load_dwordx4 v177, s[44:47], s57 offen nt lds
    s_mov_b32 m0, 6144
    s_add_u32 s57, s59, 393216
    buffer_load_dwordx4 v176, s[44:47], s57 offen nt lds
    s_mov_b32 m0, 7168
    s_add_u32 s57, s59, 458752
    buffer_load_dwordx4 v177, s[44:47], s57 offen nt lds
    s_mov_b32 m0, 8192
    s_add_u32 s57, s59, 524288
    buffer_load_dwordx4 v176, s[44:47], s57 offen nt lds
    s_mov_b32 m0, 9216
    s_add_u32 s57, s59, 589824
    buffer_load_dwordx4 v177, s[44:47], s57 offen nt lds
    s_mov_b32 m0, 10240
    s_add_u32 s57, s59, 655360
    buffer_load_dwordx4 v176, s[44:47], s57 offen nt lds
    s_mov_b32 m0, 11264
    s_add_u32 s57, s59, 720896
    buffer_load_dwordx4 v177, s[44:47], s57 offen nt lds
    s_mov_b32 m0, 12288
    s_add_u32 s57, s59, 786432
    buffer_load_dwordx4 v176, s[44:47], s57 offen nt lds
    s_mov_b32 m0, 13312
    s_add_u32 s57, s59, 851968
    buffer_load_dwordx4 v177, s[44:47], s57 offen nt lds
    s_mov_b32 m0, 14336
    s_add_u32 s57, s59, 917504
    buffer_load_dwordx4 v176, s[44:47], s57 offen nt lds
    s_mov_b32 m0, 15360
    s_add_u32 s57, s59, 983040
    buffer_load_dwordx4 v177, s[44:47], s57 offen nt lds
    s_mov_b32 m0, 16384
    s_add_u32 s57, s59, 1048576
    buffer_load_dwordx4 v176, s[44:47], s57 offen nt lds
    s_mov_b32 m0, 17408
    s_add_u32 s57, s59, 1114112
    buffer_load_dwordx4 v177, s[44:47], s57 offen nt lds
    s_mov_b32 m0, 18432
    s_add_u32 s57, s59, 1179648
    buffer_load_dwordx4 v176, s[44:47], s57 offen nt lds
    s_mov_b32 m0, 19456
    s_add_u32 s57, s59, 1245184
    buffer_load_dwordx4 v177, s[44:47], s57 offen nt lds
    s_mov_b32 m0, 20480
    s_add_u32 s57, s59, 1310720
    buffer_load_dwordx4 v176, s[44:47], s57 offen nt lds
    s_mov_b32 m0, 21504
    s_add_u32 s57, s59, 1376256
    buffer_load_dwordx4 v177, s[44:47], s57 offen nt lds
    s_mov_b32 m0, 22528
    s_add_u32 s57, s59, 1441792
    buffer_load_dwordx4 v176, s[44:47], s57 offen nt lds
    s_mov_b32 m0, 23552
    s_add_u32 s57, s59, 1507328
    buffer_load_dwordx4 v177, s[44:47], s57 offen nt lds
    s_mov_b32 m0, 24576
    s_add_u32 s57, s59, 1572864
    buffer_load_dwordx4 v176, s[44:47], s57 offen nt lds
    s_mov_b32 m0, 25600
    s_add_u32 s57, s59, 1638400
    buffer_load_dwordx4 v177, s[44:47], s57 offen nt lds
    s_mov_b32 m0, 26624
    s_add_u32 s57, s59, 1703936
    buffer_load_dwordx4 v176, s[44:47], s57 offen nt lds
    s_mov_b32 m0, 27648
    s_add_u32 s57, s59, 1769472
    buffer_load_dwordx4 v177, s[44:47], s57 offen nt lds
    s_mov_b32 m0, 28672
    s_add_u32 s57, s59, 1835008
    buffer_load_dwordx4 v176, s[44:47], s57 offen nt lds
    s_mov_b32 m0, 29696
    s_add_u32 s57, s59, 1900544
    buffer_load_dwordx4 v177, s[44:47], s57 offen nt lds
    s_mov_b32 m0, 30720
    s_add_u32 s57, s59, 1966080
    buffer_load_dwordx4 v176, s[44:47], s57 offen nt lds
    s_mov_b32 m0, 31744
    s_add_u32 s57, s59, 2031616
    buffer_load_dwordx4 v177, s[44:47], s57 offen nt lds
    s_waitcnt lgkmcnt(0)
    s_barrier
    s_mov_b32 s48, s26
    s_and_b32 s49, s27, 0xffff
    s_mov_b32 s50, 2048
    s_mov_b32 s51, 0x20000
    s_mov_b32 s52, s28
    s_and_b32 s53, s29, 0xffff
    s_mov_b32 s54, 16384
    s_mov_b32 s55, 0x20000
    v_lshlrev_b32 v1, 5, v0
    s_bfe_u32 s57, s2, 0x30001
    s_lshl_b32 s57, s57, 11
    buffer_load_dwordx4 v[96:99], v1, s[40:43], s57 offen
    buffer_load_dwordx4 v[100:103], v1, s[40:43], s57 offen offset:16
    buffer_load_dwordx4 v[104:107], v1, s[48:51], 0 offen
    buffer_load_dwordx4 v[108:111], v1, s[48:51], 0 offen offset:16
    v_lshrrev_b32 v1, 4, v0
    v_bfe_u32 v2, v0, 2, 2
    v_lshl_add_u32 v178, v1, 3, v2
    v_lshlrev_b32 v178, 7, v178
    v_bfe_u32 v1, v0, 3, 2
    v_lshl_add_u32 v178, v1, 5, v178
    v_and_b32 v1, 3, v0
    v_lshl_add_u32 v178, v1, 3, v178
    v_and_b32 v180, 7, v0
    v_lshlrev_b32 v180, 11, v180
    v_bfe_u32 v1, v0, 3, 1
    v_lshl_add_u32 v180, v1, 6, v180
    v_lshrrev_b32 v1, 4, v0
    v_lshl_add_u32 v180, v1, 4, v180
    v_mov_b32 v183, 0xffffff00
    s_add_u32 s69, s69, 1048576
    s_waitcnt vmcnt(44)
    v_readfirstlane_b32 s56, v182
    s_nop 0
    s_add_u32 s56, s56, 2654435769
    s_mov_b32 s72, s56
    s_lshr_b32 s73, s56, 8
    s_lshr_b32 s74, s56, 16
    s_lshr_b32 s75, s56, 24
    s_waitcnt vmcnt(20)
    v_xor_b32 v179, 0, v178
    ds_read_b64_tr_b16 v[40:41], v179 offset:0
    ds_read_b64_tr_b16 v[42:43], v179 offset:512
    ds_read_b64_tr_b16 v[44:45], v179 offset:4096
    ds_read_b64_tr_b16 v[46:47], v179 offset:4608
    ds_read_b64_tr_b16 v[48:49], v179 offset:8192
    ds_read_b64_tr_b16 v[50:51], v179 offset:8704
    ds_read_b64_tr_b16 v[52:53], v179 offset:12288
    ds_read_b64_tr_b16 v[54:55], v179 offset:12800
    s_waitcnt lgkmcnt(0)
    v_xor_b32 v179, 32, v178
    ds_read_b64_tr_b16 v[56:57], v179 offset:0
    ds_read_b64_tr_b16 v[58:59], v179 offset:512
    ds_read_b64_tr_b16 v[60:61], v179 offset:4096
    ds_read_b64_tr_b16 v[62:63], v179 offset:4608
    ds_read_b64_tr_b16 v[64:65], v179 offset:8192
    ds_read_b64_tr_b16 v[66:67], v179 offset:8704
    ds_read_b64_tr_b16 v[68:69], v179 offset:12288
    ds_read_b64_tr_b16 v[70:71], v179 offset:12800
    v_mfma_f32_16x16x32_bf16 v[72:75], v[40:43], v[8:11], 0
    v_mfma_f32_16x16x32_bf16 v[72:75], v[44:47], v[12:15], v[72:75]
    v_mfma_f32_16x16x32_bf16 v[72:75], v[48:51], v[16:19], v[72:75]
    v_mfma_f32_16x16x32_bf16 v[72:75], v[52:55], v[20:23], v[72:75]
    s_waitcnt lgkmcnt(0)
    v_xor_b32 v179, 64, v178
    ds_read_b64_tr_b16 v[40:41], v179 offset:0
    ds_read_b64_tr_b16 v[42:43], v179 offset:512
    ds_read_b64_tr_b16 v[44:45], v179 offset:4096
    ds_read_b64_tr_b16 v[46:47], v179 offset:4608
    ds_read_b64_tr_b16 v[48:49], v179 offset:8192
    ds_read_b64_tr_b16 v[50:51], v179 offset:8704
    ds_read_b64_tr_b16 v[52:53], v179 offset:12288
    ds_read_b64_tr_b16 v[54:55], v179 offset:12800
    v_mfma_f32_16x16x32_bf16 v[76:79], v[56:59], v[8:11], 0
    v_mfma_f32_16x16x32_bf16 v[76:79], v[60:63], v[12:15], v[76:79]
    v_mfma_f32_16x16x32_bf16 v[76:79], v[64:67], v[16:19], v[76:79]
    v_mfma_f32_16x16x32_bf16 v[76:79], v[68:71], v[20:23], v[76:79]
    s_waitcnt lgkmcnt(0)
    v_xor_b32 v179, 96, v178
    ds_read_b64_tr_b16 v[56:57], v179 offset:0
    ds_read_b64_tr_b16 v[58:59], v179 offset:512
    ds_read_b64_tr_b16 v[60:61], v179 offset:4096
    ds_read_b64_tr_b16 v[62:63], v179 offset:4608
    ds_read_b64_tr_b16 v[64:65], v179 offset:8192
    ds_read_b64_tr_b16 v[66:67], v179 offset:8704
    ds_read_b64_tr_b16 v[68:69], v179 offset:12288
    ds_read_b64_tr_b16 v[70:71], v179 offset:12800
    v_mfma_f32_16x16x32_bf16 v[80:83], v[40:43], v[8:11], 0
    v_mfma_f32_16x16x32_bf16 v[80:83], v[44:47], v[12:15], v[80:83]
    v_mfma_f32_16x16x32_bf16 v[80:83], v[48:51], v[16:19], v[80:83]
    v_mfma_f32_16x16x32_bf16 v[80:83], v[52:55], v[20:23], v[80:83]
    s_waitcnt lgkmcnt(0)
    s_waitcnt vmcnt(4)
    v_xor_b32 v179, 0, v178
    ds_read_b64_tr_b16 v[40:41], v179 offset:16384
    ds_read_b64_tr_b16 v[42:43], v179 offset:16896
    ds_read_b64_tr_b16 v[44:45], v179 offset:20480
    ds_read_b64_tr_b16 v[46:47], v179 offset:20992
    ds_read_b64_tr_b16 v[48:49], v179 offset:24576
    ds_read_b64_tr_b16 v[50:51], v179 offset:25088
    ds_read_b64_tr_b16 v[52:53], v179 offset:28672
    ds_read_b64_tr_b16 v[54:55], v179 offset:29184
    v_mfma_f32_16x16x32_bf16 v[84:87], v[56:59], v[8:11], 0
    v_mfma_f32_16x16x32_bf16 v[84:87], v[60:63], v[12:15], v[84:87]
    v_mfma_f32_16x16x32_bf16 v[84:87], v[64:67], v[16:19], v[84:87]
    v_mfma_f32_16x16x32_bf16 v[84:87], v[68:71], v[20:23], v[84:87]
    s_waitcnt lgkmcnt(0)
    v_xor_b32 v179, 32, v178
    ds_read_b64_tr_b16 v[56:57], v179 offset:16384
    ds_read_b64_tr_b16 v[58:59], v179 offset:16896
    ds_read_b64_tr_b16 v[60:61], v179 offset:20480
    ds_read_b64_tr_b16 v[62:63], v179 offset:20992
    ds_read_b64_tr_b16 v[64:65], v179 offset:24576
    ds_read_b64_tr_b16 v[66:67], v179 offset:25088
    ds_read_b64_tr_b16 v[68:69], v179 offset:28672
    ds_read_b64_tr_b16 v[70:71], v179 offset:29184
    v_mfma_f32_16x16x32_bf16 v[72:75], v[40:43], v[24:27], v[72:75]
    v_mfma_f32_16x16x32_bf16 v[72:75], v[44:47], v[28:31], v[72:75]
    v_mfma_f32_16x16x32_bf16 v[72:75], v[48:51], v[32:35], v[72:75]
    v_mfma_f32_16x16x32_bf16 v[72:75], v[52:55], v[36:39], v[72:75]
    s_waitcnt lgkmcnt(0)
    v_xor_b32 v179, 64, v178
    ds_read_b64_tr_b16 v[40:41], v179 offset:16384
    ds_read_b64_tr_b16 v[42:43], v179 offset:16896
    ds_read_b64_tr_b16 v[44:45], v179 offset:20480
    ds_read_b64_tr_b16 v[46:47], v179 offset:20992
    ds_read_b64_tr_b16 v[48:49], v179 offset:24576
    ds_read_b64_tr_b16 v[50:51], v179 offset:25088
    ds_read_b64_tr_b16 v[52:53], v179 offset:28672
    ds_read_b64_tr_b16 v[54:55], v179 offset:29184
    v_mfma_f32_16x16x32_bf16 v[76:79], v[56:59], v[24:27], v[76:79]
    v_mfma_f32_16x16x32_bf16 v[76:79], v[60:63], v[28:31], v[76:79]
    v_mfma_f32_16x16x32_bf16 v[76:79], v[64:67], v[32:35], v[76:79]
    v_mfma_f32_16x16x32_bf16 v[76:79], v[68:71], v[36:39], v[76:79]
    s_waitcnt lgkmcnt(0)
    v_xor_b32 v179, 96, v178
    ds_read_b64_tr_b16 v[56:57], v179 offset:16384
    ds_read_b64_tr_b16 v[58:59], v179 offset:16896
    ds_read_b64_tr_b16 v[60:61], v179 offset:20480
    ds_read_b64_tr_b16 v[62:63], v179 offset:20992
    ds_read_b64_tr_b16 v[64:65], v179 offset:24576
    ds_read_b64_tr_b16 v[66:67], v179 offset:25088
    ds_read_b64_tr_b16 v[68:69], v179 offset:28672
    ds_read_b64_tr_b16 v[70:71], v179 offset:29184
    v_mfma_f32_16x16x32_bf16 v[80:83], v[40:43], v[24:27], v[80:83]
    v_mfma_f32_16x16x32_bf16 v[80:83], v[44:47], v[28:31], v[80:83]
    v_mfma_f32_16x16x32_bf16 v[80:83], v[48:51], v[32:35], v[80:83]
    v_mfma_f32_16x16x32_bf16 v[80:83], v[52:55], v[36:39], v[80:83]
    s_waitcnt lgkmcnt(0)
    v_mfma_f32_16x16x32_bf16 v[84:87], v[56:59], v[24:27], v[84:87]
    v_mfma_f32_16x16x32_bf16 v[84:87], v[60:63], v[28:31], v[84:87]
    v_mfma_f32_16x16x32_bf16 v[84:87], v[64:67], v[32:35], v[84:87]
    v_mfma_f32_16x16x32_bf16 v[84:87], v[68:71], v[36:39], v[84:87]
    v_cndmask_b32 v72, v72, v76, s[60:61]
    v_cndmask_b32 v73, v73, v77, s[60:61]
    v_cndmask_b32 v74, v74, v78, s[60:61]
    v_cndmask_b32 v75, v75, v79, s[60:61]
    v_add_u32 v1, 0x80, v72
    v_bfi_b32 v88, v183, v1, s72
    v_add_u32 v1, 0x80, v73
    v_bfi_b32 v89, v183, v1, s73
    v_add_u32 v1, 0x80, v74
    v_bfi_b32 v90, v183, v1, s74
    v_add_u32 v1, 0x80, v75
    v_bfi_b32 v91, v183, v1, s75
    buffer_store_dwordx4 v[88:91], v180, s[36:39], s69 offen offset:0 sc1
    v_cndmask_b32 v80, v80, v84, s[60:61]
    v_cndmask_b32 v81, v81, v85, s[60:61]
    v_cndmask_b32 v82, v82, v86, s[60:61]
    v_cndmask_b32 v83, v83, v87, s[60:61]
    v_add_u32 v1, 0x80, v80
    v_bfi_b32 v92, v183, v1, s72
    v_add_u32 v1, 0x80, v81
    v_bfi_b32 v93, v183, v1, s73
    v_add_u32 v1, 0x80, v82
    v_bfi_b32 v94, v183, v1, s74
    v_add_u32 v1, 0x80, v83
    v_bfi_b32 v95, v183, v1, s75
    buffer_store_dwordx4 v[92:95], v180, s[36:39], s69 offen offset:128 sc1
    s_lshl_b32 s70, s5, 3
    s_add_u32 s70, s70, s4
    s_lshl_b32 s59, s70, 11
    s_add_u32 s59, s59, 1048576
    v_lshlrev_b32 v181, 4, v0
    s_sleep 80
    s_mov_b32 s58, 200000
    s_mov_b64 s[8:9], -1
    s_mov_b64 s[10:11], -1
L_poll0:
    s_mov_b64 exec, s[8:9]
    s_cbranch_execz L_pskip0_0
    buffer_load_dwordx4 v[112:115], v181, s[36:39], s59 offen sc1
L_pskip0_0:
    s_mov_b64 exec, s[10:11]
    s_cbranch_execz L_pskip0_1
    buffer_load_dwordx4 v[116:119], v181, s[36:39], s59 offen offset:1024 sc1
L_pskip0_1:
    s_mov_b64 exec, -1
    s_waitcnt vmcnt(0)
    v_xor_b32 v1, s72, v112
    v_xor_b32 v2, s73, v113
    v_or_b32 v3, v1, v2
    v_xor_b32 v1, s74, v114
    v_xor_b32 v2, s75, v115
    v_or3_b32 v3, v3, v1, v2
    v_and_b32 v3, 0xff, v3
    v_cmp_ne_u32 s[8:9], 0, v3
    v_xor_b32 v1, s72, v116
    v_xor_b32 v2, s73, v117
    v_or_b32 v3, v1, v2
    v_xor_b32 v1, s74, v118
    v_xor_b32 v2, s75, v119
    v_or3_b32 v3, v3, v1, v2
    v_and_b32 v3, 0xff, v3
    v_cmp_ne_u32 s[10:11], 0, v3
    s_mov_b64 s[66:67], s[8:9]
    s_or_b64 s[66:67], s[66:67], s[10:11]
    s_cmp_eq_u64 s[66:67], 0
    s_cbranch_scc1 L_pdone0
    s_sub_u32 s58, s58, 1
    s_cmp_eq_u32 s58, 0
    s_cbranch_scc1 L_pdone0
    s_sleep 1
    s_branch L_poll0
L_pdone0:
    v_and_b32 v112, 0xffffff00, v112
    v_and_b32 v113, 0xffffff00, v113
    v_and_b32 v114, 0xffffff00, v114
    v_and_b32 v115, 0xffffff00, v115
    v_and_b32 v116, 0xffffff00, v116
    v_and_b32 v117, 0xffffff00, v117
    v_and_b32 v118, 0xffffff00, v118
    v_and_b32 v119, 0xffffff00, v119
    v_add_f32 v112, v112, v116
    v_add_f32 v113, v113, v117
    v_add_f32 v114, v114, v118
    v_add_f32 v115, v115, v119
    v_mov_b32 v1, v112
    s_nop 1
    v_permlane32_swap_b32 v112, v1
    v_add_f32 v112, v112, v1
    v_mov_b32 v1, v113
    s_nop 1
    v_permlane32_swap_b32 v113, v1
    v_add_f32 v113, v113, v1
    v_mov_b32 v1, v114
    s_nop 1
    v_permlane32_swap_b32 v114, v1
    v_add_f32 v114, v114, v1
    v_mov_b32 v1, v115
    s_nop 1
    v_permlane32_swap_b32 v115, v1
    v_add_f32 v115, v115, v1
    v_cvt_pk_bf16_f32 v116, v112, v113
    v_cvt_pk_bf16_f32 v117, v114, v115
    v_and_b32 v2, 31, v0
    v_lshlrev_b32 v2, 3, v2
    v_add_u32 v2, 98304, v2
    ds_write_b64 v2, v[116:117]
    s_waitcnt lgkmcnt(0)
    v_mov_b32 v1, 98560
    v_mov_b32 v2, 1
    ds_write_b32 v1, v2
    v_mov_b32 v5, 0
    v_lshlrev_b32 v1, 16, v96
    v_and_b32 v2, 0xffff0000, v96
    v_lshlrev_b32 v3, 16, v104
    v_and_b32 v4, 0xffff0000, v104
    v_mul_f32 v1, v1, v3
    v_mul_f32 v2, v2, v4
    v_cvt_pk_bf16_f32 v1, v1, v2
    v_lshlrev_b32 v2, 16, v1
    v_and_b32 v1, 0xffff0000, v1
    v_add_f32 v5, v5, v2
    v_add_f32 v5, v5, v1
    v_lshlrev_b32 v1, 16, v97
    v_and_b32 v2, 0xffff0000, v97
    v_lshlrev_b32 v3, 16, v105
    v_and_b32 v4, 0xffff0000, v105
    v_mul_f32 v1, v1, v3
    v_mul_f32 v2, v2, v4
    v_cvt_pk_bf16_f32 v1, v1, v2
    v_lshlrev_b32 v2, 16, v1
    v_and_b32 v1, 0xffff0000, v1
    v_add_f32 v5, v5, v2
    v_add_f32 v5, v5, v1
    v_lshlrev_b32 v1, 16, v98
    v_and_b32 v2, 0xffff0000, v98
    v_lshlrev_b32 v3, 16, v106
    v_and_b32 v4, 0xffff0000, v106
    v_mul_f32 v1, v1, v3
    v_mul_f32 v2, v2, v4
    v_cvt_pk_bf16_f32 v1, v1, v2
    v_lshlrev_b32 v2, 16, v1
    v_and_b32 v1, 0xffff0000, v1
    v_add_f32 v5, v5, v2
    v_add_f32 v5, v5, v1
    v_lshlrev_b32 v1, 16, v99
    v_and_b32 v2, 0xffff0000, v99
    v_lshlrev_b32 v3, 16, v107
    v_and_b32 v4, 0xffff0000, v107
    v_mul_f32 v1, v1, v3
    v_mul_f32 v2, v2, v4
    v_cvt_pk_bf16_f32 v1, v1, v2
    v_lshlrev_b32 v2, 16, v1
    v_and_b32 v1, 0xffff0000, v1
    v_add_f32 v5, v5, v2
    v_add_f32 v5, v5, v1
    v_lshlrev_b32 v1, 16, v100
    v_and_b32 v2, 0xffff0000, v100
    v_lshlrev_b32 v3, 16, v108
    v_and_b32 v4, 0xffff0000, v108
    v_mul_f32 v1, v1, v3
    v_mul_f32 v2, v2, v4
    v_cvt_pk_bf16_f32 v1, v1, v2
    v_lshlrev_b32 v2, 16, v1
    v_and_b32 v1, 0xffff0000, v1
    v_add_f32 v5, v5, v2
    v_add_f32 v5, v5, v1
    v_lshlrev_b32 v1, 16, v101
    v_and_b32 v2, 0xffff0000, v101
    v_lshlrev_b32 v3, 16, v109
    v_and_b32 v4, 0xffff0000, v109
    v_mul_f32 v1, v1, v3
    v_mul_f32 v2, v2, v4
    v_cvt_pk_bf16_f32 v1, v1, v2
    v_lshlrev_b32 v2, 16, v1
    v_and_b32 v1, 0xffff0000, v1
    v_add_f32 v5, v5, v2
    v_add_f32 v5, v5, v1
    v_lshlrev_b32 v1, 16, v102
    v_and_b32 v2, 0xffff0000, v102
    v_lshlrev_b32 v3, 16, v110
    v_and_b32 v4, 0xffff0000, v110
    v_mul_f32 v1, v1, v3
    v_mul_f32 v2, v2, v4
    v_cvt_pk_bf16_f32 v1, v1, v2
    v_lshlrev_b32 v2, 16, v1
    v_and_b32 v1, 0xffff0000, v1
    v_add_f32 v5, v5, v2
    v_add_f32 v5, v5, v1
    v_lshlrev_b32 v1, 16, v103
    v_and_b32 v2, 0xffff0000, v103
    v_lshlrev_b32 v3, 16, v111
    v_and_b32 v4, 0xffff0000, v111
    v_mul_f32 v1, v1, v3
    v_mul_f32 v2, v2, v4
    v_cvt_pk_bf16_f32 v1, v1, v2
    v_lshlrev_b32 v2, 16, v1
    v_and_b32 v1, 0xffff0000, v1
    v_add_f32 v5, v5, v2
    v_add_f32 v5, v5, v1
    s_nop 1
    v_add_f32_dpp v5, v5, v5 row_ror:8 row_mask:0xf bank_mask:0xf
    s_nop 1
    v_add_f32_dpp v5, v5, v5 row_ror:4 row_mask:0xf bank_mask:0xf
    s_nop 1
    v_add_f32_dpp v5, v5, v5 row_ror:2 row_mask:0xf bank_mask:0xf
    s_nop 1
    v_add_f32_dpp v5, v5, v5 row_ror:1 row_mask:0xf bank_mask:0xf
    v_mov_b32 v1, v5
    s_nop 1
    v_permlane16_swap_b32 v5, v1
    v_add_f32 v5, v5, v1
    v_mov_b32 v1, v5
    s_nop 1
    v_permlane32_swap_b32 v5, v1
    v_add_f32 v5, v5, v1
    v_cvt_pk_bf16_f32 v5, v5, v5
    v_lshlrev_b32 v5, 16, v5
    v_mul_f32 v5, s68, v5
    v_exp_f32 v5, -v5
    s_nop 0
    v_add_f32 v5, 1.0, v5
    v_rcp_f32 v5, v5
    s_nop 0
    v_cvt_pk_bf16_f32 v6, v5, v5
    v_lshlrev_b32 v6, 16, v6
    v_sub_f32 v7, 1.0, v6
    v_cvt_pk_bf16_f32 v7, v7, v7
    v_lshlrev_b32 v7, 16, v7
    v_lshrrev_b32 v1, 3, v0
    v_lshlrev_b32 v1, 11, v1
    v_and_b32 v2, 7, v0
    v_lshl_add_u32 v8, v2, 4, v1
    s_lshr_b32 s57, s2, 4
    s_lshl_b32 s69, s57, 15
    s_bfe_u32 s57, s2, 0x30001
    s_lshl_b32 s57, s57, 8
    s_add_u32 s69, s69, s57
    s_and_b32 s57, s2, 1
    s_lshl_b32 s57, s57, 7
    s_add_u32 s69, s69, s57
    v_lshrrev_b32 v1, 2, v0
    v_lshlrev_b32 v9, 4, v1
    v_bfe_u32 v1, v0, 1, 1
    v_lshl_add_u32 v9, v1, 8, v9
    v_and_b32 v1, 1, v0
    v_lshl_add_u32 v9, v1, 3, v9
    v_add_u32 v9, 99328, v9
    v_add_u32 v40, 2048, v9
    v_mov_b32 v41, 98816
    v_lshlrev_b32 v10, 3, v0
    s_lshl_b32 s70, s70, 9
    s_add_u32 s70, s70, 7340032
    v_mov_b32 v43, s56
    v_lshrrev_b32 v1, 5, v0
    v_mul_u32_u24 v11, 272, v1
    v_and_b32 v1, 31, v0
    v_lshl_add_u32 v11, v1, 3, v11
    v_add_u32 v11, 103424, v11
    s_and_b32 s57, s2, 7
    s_lshr_b32 s58, s2, 3
    s_lshl_b32 s6, s57, 1
    s_lshr_b32 s57, s58, 4
    s_add_u32 s6, s6, s57
    s_add_u32 s7, s58, 7
    s_and_b32 s7, s7, 15
    s_lshl_b32 s57, s6, 13
    s_add_u32 s24, s57, 7340032
    s_add_u32 s25, s24, 4096
    s_mov_b32 s28, s30
    s_and_b32 s29, s31, 0xffff
    s_mov_b32 s30, 256
    s_mov_b32 s31, 0x20000
    s_mov_b32 s58, 12800000
    v_mov_b32 v44, 98580
L_ag0:
    ds_read_b32 v46, v44
    s_waitcnt lgkmcnt(0)
    v_readfirstlane_b32 s57, v46
    s_nop 0
    s_cmp_lg_u32 s57, 0
    s_cbranch_scc1 L_agdo0
    s_sub_u32 s58, s58, 1
    s_cmp_eq_u32 s58, 0
    s_cbranch_scc1 L_agend
    s_sleep 4
    s_branch L_ag0
L_agdo0:
    v_mov_b32 v45, 1
    s_mov_b64 exec, 1
    buffer_atomic_add v45, off, s[28:31], 0 offset:0 sc0 sc1
    s_mov_b64 exec, -1
    s_waitcnt vmcnt(0)
    v_readfirstlane_b32 s57, v45
    s_mov_b32 s59, 196610
    s_cmp_lt_u32 s57, 248
    s_cselect_b32 s59, 65540, s59
    s_cmp_lt_u32 s57, 232
    s_cselect_b32 s59, 5, s59
    s_cmp_lt_u32 s57, 212
    s_cselect_b32 s59, 3, s59
    s_cmp_lt_u32 s57, 185
    s_cselect_b32 s59, 2, s59
    s_cmp_lt_u32 s57, 150
    s_cselect_b32 s59, 0, s59
    s_cmp_lt_u32 s57, 70
    s_cselect_b32 s59, 256, s59
    s_cmp_lt_u32 s57, 20
    s_cselect_b32 s59, 512, s59
    v_mov_b32 v45, s59
    v_mov_b32 v44, 98576
    ds_write_b32 v44, v45
    v_mov_b32 v44, 98588
L_ag1:
    ds_read_b32 v46, v44
    s_waitcnt lgkmcnt(0)
    v_readfirstlane_b32 s57, v46
    s_nop 0
    s_cmp_lg_u32 s57, 0
    s_cbranch_scc1 L_agdo1
    s_sub_u32 s58, s58, 1
    s_cmp_eq_u32 s58, 0
    s_cbranch_scc1 L_agend
    s_sleep 4
    s_branch L_ag1
L_agdo1:
    v_mov_b32 v45, 1
    s_mov_b64 exec, 1
    buffer_atomic_add v45, off, s[28:31], 0 offset:128 sc0 sc1
    s_mov_b64 exec, -1
    s_waitcnt vmcnt(0)
    v_readfirstlane_b32 s57, v45
    s_mov_b32 s59, 131072
    s_cmp_lt_u32 s57, 235
    s_cselect_b32 s59, 65537, s59
    s_cmp_lt_u32 s57, 210
    s_cselect_b32 s59, 2, s59
    s_cmp_lt_u32 s57, 185
    s_cselect_b32 s59, 1, s59
    s_cmp_lt_u32 s57, 150
    s_cselect_b32 s59, 0, s59
    s_cmp_lt_u32 s57, 85
    s_cselect_b32 s59, 256, s59
    s_cmp_lt_u32 s57, 24
    s_cselect_b32 s59, 512, s59
    v_mov_b32 v45, s59
    v_mov_b32 v44, 98584
    ds_write_b32 v44, v45
L_agend:
    s_barrier
    ds_read2_b64 v[24:27], v9 offset0:0 offset1:64
    ds_read2_b64 v[28:31], v9 offset0:128 offset1:192
    s_waitcnt lgkmcnt(0)
    v_add_f32 v24, v24, v26
    v_add_f32 v25, v25, v27
    v_add_f32 v28, v28, v30
    v_add_f32 v29, v29, v31
    v_add_f32 v3, v24, v28
    v_add_f32 v4, v25, v29
    v_cvt_pk_bf16_f32 v42, v3, v4
    buffer_store_dwordx2 v[42:43], v10, s[36:39], s70 offen sc1
    s_add_u32 s59, s69, 5242880
    s_add_u32 s71, s69, 5259264
    buffer_load_dwordx4 v[144:147], v8, s[36:39], s59 offen sc1
    buffer_load_dwordx4 v[148:151], v8, s[36:39], s71 offen sc1
    s_mov_b32 s58, 200000
    s_mov_b64 s[8:9], -1
    s_mov_b64 s[10:11], -1
    s_mov_b64 s[12:13], -1
    s_mov_b64 s[14:15], -1
    s_mov_b64 s[16:17], -1
    s_mov_b64 s[18:19], -1
    s_mov_b64 s[20:21], -1
    s_mov_b64 s[22:23], -1
L_poll1:
    s_mov_b64 exec, s[8:9]
    s_cbranch_execz L_pskip1_0
    buffer_load_dwordx4 v[112:115], v181, s[36:39], s24 offen offset:0 sc1
L_pskip1_0:
    s_mov_b64 exec, s[10:11]
    s_cbranch_execz L_pskip1_1
    buffer_load_dwordx4 v[116:119], v181, s[36:39], s24 offen offset:1024 sc1
L_pskip1_1:
    s_mov_b64 exec, s[12:13]
    s_cbranch_execz L_pskip1_2
    buffer_load_dwordx4 v[120:123], v181, s[36:39], s24 offen offset:2048 sc1
L_pskip1_2:
    s_mov_b64 exec, s[14:15]
    s_cbranch_execz L_pskip1_3
    buffer_load_dwordx4 v[124:127], v181, s[36:39], s24 offen offset:3072 sc1
L_pskip1_3:
    s_mov_b64 exec, s[16:17]
    s_cbranch_execz L_pskip1_4
    buffer_load_dwordx4 v[128:131], v181, s[36:39], s25 offen offset:0 sc1
L_pskip1_4:
    s_mov_b64 exec, s[18:19]
    s_cbranch_execz L_pskip1_5
    buffer_load_dwordx4 v[132:135], v181, s[36:39], s25 offen offset:1024 sc1
L_pskip1_5:
    s_mov_b64 exec, s[20:21]
    s_cbranch_execz L_pskip1_6
    buffer_load_dwordx4 v[136:139], v181, s[36:39], s25 offen offset:2048 sc1
L_pskip1_6:
    s_mov_b64 exec, s[22:23]
    s_cbranch_execz L_pskip1_7
    buffer_load_dwordx4 v[140:143], v181, s[36:39], s25 offen offset:3072 sc1
L_pskip1_7:
    s_mov_b64 exec, -1
    s_waitcnt vmcnt(0)
    v_xor_b32 v1, s56, v113
    v_xor_b32 v2, s56, v115
    v_or_b32 v3, v1, v2
    v_cmp_ne_u32 s[8:9], 0, v3
    v_xor_b32 v1, s56, v117
    v_xor_b32 v2, s56, v119
    v_or_b32 v3, v1, v2
    v_cmp_ne_u32 s[10:11], 0, v3
    v_xor_b32 v1, s56, v121
    v_xor_b32 v2, s56, v123
    v_or_b32 v3, v1, v2
    v_cmp_ne_u32 s[12:13], 0, v3
    v_xor_b32 v1, s56, v125
    v_xor_b32 v2, s56, v127
    v_or_b32 v3, v1, v2
    v_cmp_ne_u32 s[14:15], 0, v3
    v_xor_b32 v1, s56, v129
    v_xor_b32 v2, s56, v131
    v_or_b32 v3, v1, v2
    v_cmp_ne_u32 s[16:17], 0, v3
    v_xor_b32 v1, s56, v133
    v_xor_b32 v2, s56, v135
    v_or_b32 v3, v1, v2
    v_cmp_ne_u32 s[18:19], 0, v3
    v_xor_b32 v1, s56, v137
    v_xor_b32 v2, s56, v139
    v_or_b32 v3, v1, v2
    v_cmp_ne_u32 s[20:21], 0, v3
    v_xor_b32 v1, s56, v141
    v_xor_b32 v2, s56, v143
    v_or_b32 v3, v1, v2
    v_cmp_ne_u32 s[22:23], 0, v3
    s_mov_b64 s[66:67], s[8:9]
    s_or_b64 s[66:67], s[66:67], s[10:11]
    s_or_b64 s[66:67], s[66:67], s[12:13]
    s_or_b64 s[66:67], s[66:67], s[14:15]
    s_or_b64 s[66:67], s[66:67], s[16:17]
    s_or_b64 s[66:67], s[66:67], s[18:19]
    s_or_b64 s[66:67], s[66:67], s[20:21]
    s_or_b64 s[66:67], s[66:67], s[22:23]
    s_cmp_eq_u64 s[66:67], 0
    s_cbranch_scc1 L_pdone1
    s_sub_u32 s58, s58, 1
    s_cmp_eq_u32 s58, 0
    s_cbranch_scc1 L_pdone1
    s_sleep 1
    s_branch L_poll1
L_pdone1:
    v_mov_b32 v113, v114
    ds_write_b64 v11, v[112:113] offset:0
    v_mov_b32 v117, v118
    ds_write_b64 v11, v[116:117] offset:544
    v_mov_b32 v121, v122
    ds_write_b64 v11, v[120:121] offset:1088
    v_mov_b32 v125, v126
    ds_write_b64 v11, v[124:125] offset:1632
    v_mov_b32 v129, v130
    ds_write_b64 v11, v[128:129] offset:2176
    v_mov_b32 v133, v134
    ds_write_b64 v11, v[132:133] offset:2720
    v_mov_b32 v137, v138
    ds_write_b64 v11, v[136:137] offset:3264
    v_mov_b32 v141, v142
    ds_write_b64 v11, v[140:141] offset:3808
    s_waitcnt lgkmcnt(0)
    s_barrier
    s_add_u32 s59, s69, 5242880
    s_add_u32 s71, s69, 5259264
    s_mov_b32 s26, s59
    s_mov_b32 s27, s71
    s_add_u32 s59, s69, 4194304
    s_add_u32 s71, s69, 4210688
    s_bfe_u32 s57, s2, 0x30001
    s_lshl_b32 s34, s57, 11
    s_lshr_b32 s57, s2, 4
    s_lshl_b32 s57, s57, 7
    s_add_u32 s34, s34, s57
    s_and_b32 s57, s2, 1
    s_lshl_b32 s57, s57, 6
    s_add_u32 s34, s34, s57
    s_mov_b64 s[8:9], 0
    s_mov_b64 s[10:11], 0
    s_mov_b64 s[12:13], -1
    s_mov_b64 s[14:15], -1
    s_mov_b32 s58, 200000
L_poll2:
    s_mov_b64 exec, s[8:9]
    s_cbranch_execz L_pskip2_0
    buffer_load_dwordx4 v[144:147], v8, s[36:39], s26 offen sc1
L_pskip2_0:
    s_mov_b64 exec, s[10:11]
    s_cbranch_execz L_pskip2_1
    buffer_load_dwordx4 v[148:151], v8, s[36:39], s27 offen sc1
L_pskip2_1:
    s_mov_b64 exec, s[12:13]
    s_cbranch_execz L_pskip2_2
    buffer_load_dwordx4 v[112:115], v8, s[36:39], s59 offen sc1
L_pskip2_2:
    s_mov_b64 exec, s[14:15]
    s_cbranch_execz L_pskip2_3
    buffer_load_dwordx4 v[116:119], v8, s[36:39], s71 offen sc1
L_pskip2_3:
    s_mov_b64 exec, -1
    s_waitcnt vmcnt(0)
    v_xor_b32 v1, s72, v144
    v_xor_b32 v2, s73, v145
    v_or_b32 v3, v1, v2
    v_xor_b32 v1, s74, v146
    v_xor_b32 v2, s75, v147
    v_or3_b32 v3, v3, v1, v2
    v_and_b32 v3, 0xff, v3
    v_cmp_ne_u32 s[8:9], 0, v3
    v_xor_b32 v1, s72, v148
    v_xor_b32 v2, s73, v149
    v_or_b32 v3, v1, v2
    v_xor_b32 v1, s74, v150
    v_xor_b32 v2, s75, v151
    v_or3_b32 v3, v3, v1, v2
    v_and_b32 v3, 0xff, v3
    v_cmp_ne_u32 s[10:11], 0, v3
    v_xor_b32 v1, s72, v112
    v_xor_b32 v2, s73, v113
    v_or_b32 v3, v1, v2
    v_xor_b32 v1, s74, v114
    v_xor_b32 v2, s75, v115
    v_or3_b32 v3, v3, v1, v2
    v_and_b32 v3, 0xff, v3
    v_cmp_ne_u32 s[12:13], 0, v3
    v_xor_b32 v1, s72, v116
    v_xor_b32 v2, s73, v117
    v_or_b32 v3, v1, v2
    v_xor_b32 v1, s74, v118
    v_xor_b32 v2, s75, v119
    v_or3_b32 v3, v3, v1, v2
    v_and_b32 v3, 0xff, v3
    v_cmp_ne_u32 s[14:15], 0, v3
    s_mov_b64 s[66:67], s[8:9]
    s_or_b64 s[66:67], s[66:67], s[10:11]
    s_cmp_eq_u64 s[66:67], 0
    s_cbranch_scc1 L_pdone2
    s_sub_u32 s58, s58, 1
    s_cmp_eq_u32 s58, 0
    s_cbranch_scc1 L_pdone2
    s_sleep 1
    s_branch L_poll2
L_pdone2:
    v_and_b32 v144, 0xffffff00, v144
    v_and_b32 v145, 0xffffff00, v145
    v_and_b32 v146, 0xffffff00, v146
    v_and_b32 v147, 0xffffff00, v147
    v_and_b32 v148, 0xffffff00, v148
    v_and_b32 v149, 0xffffff00, v149
    v_and_b32 v150, 0xffffff00, v150
    v_and_b32 v151, 0xffffff00, v151
    v_add_f32 v144, v144, v148
    v_add_f32 v145, v145, v149
    v_add_f32 v146, v146, v150
    v_add_f32 v147, v147, v151
    v_add_f32_dpp v144, v144, v144 row_ror:8 row_mask:0xf bank_mask:0xf
    v_add_f32_dpp v145, v145, v145 row_ror:8 row_mask:0xf bank_mask:0xf
    v_add_f32_dpp v146, v146, v146 row_ror:8 row_mask:0xf bank_mask:0xf
    v_add_f32_dpp v147, v147, v147 row_ror:8 row_mask:0xf bank_mask:0xf
    v_mov_b32 v148, v144
    v_mov_b32 v149, v145
    v_mov_b32 v150, v146
    v_mov_b32 v151, v147
    v_permlane16_swap_b32 v144, v148
    v_permlane16_swap_b32 v145, v149
    v_permlane16_swap_b32 v146, v150
    v_permlane16_swap_b32 v147, v151
    v_add_f32 v144, v144, v148
    v_add_f32 v145, v145, v149
    v_add_f32 v146, v146, v150
    v_add_f32 v147, v147, v151
    v_mov_b32 v148, v144
    v_mov_b32 v149, v145
    v_mov_b32 v150, v146
    v_mov_b32 v151, v147
    v_permlane32_swap_b32 v144, v148
    v_permlane32_swap_b32 v145, v149
    v_permlane32_swap_b32 v146, v150
    v_permlane32_swap_b32 v147, v151
    v_add_f32 v144, v144, v148
    v_add_f32 v145, v145, v149
    v_add_f32 v146, v146, v150
    v_add_f32 v147, v147, v151
    v_cvt_pk_bf16_f32 v12, v144, v144
    v_cvt_pk_bf16_f32 v13, v145, v145
    v_cvt_pk_bf16_f32 v14, v146, v146
    v_cvt_pk_bf16_f32 v15, v147, v147
    v_lshlrev_b32 v12, 16, v12
    v_lshlrev_b32 v13, 16, v13
    v_lshlrev_b32 v14, 16, v14
    v_lshlrev_b32 v15, 16, v15
    v_mul_f32 v12, v7, v12
    v_mul_f32 v13, v7, v13
    v_mul_f32 v14, v7, v14
    v_mul_f32 v15, v7, v15
    v_cvt_pk_bf16_f32 v12, v12, v12
    v_cvt_pk_bf16_f32 v13, v13, v13
    v_cvt_pk_bf16_f32 v14, v14, v14
    v_cvt_pk_bf16_f32 v15, v15, v15
    v_lshlrev_b32 v12, 16, v12
    v_lshlrev_b32 v13, 16, v13
    v_lshlrev_b32 v14, 16, v14
    v_lshlrev_b32 v15, 16, v15
    s_or_b64 s[66:67], s[12:13], s[14:15]
    s_cbranch_scc0 L_adone
    s_mov_b32 s58, 200000
L_poll3:
    s_mov_b64 exec, s[12:13]
    s_cbranch_execz L_pskip3_0
    buffer_load_dwordx4 v[112:115], v8, s[36:39], s59 offen sc1
L_pskip3_0:
    s_mov_b64 exec, s[14:15]
    s_cbranch_execz L_pskip3_1
    buffer_load_dwordx4 v[116:119], v8, s[36:39], s71 offen sc1
L_pskip3_1:
    s_mov_b64 exec, -1
    s_waitcnt vmcnt(0)
    v_xor_b32 v1, s72, v112
    v_xor_b32 v2, s73, v113
    v_or_b32 v3, v1, v2
    v_xor_b32 v1, s74, v114
    v_xor_b32 v2, s75, v115
    v_or3_b32 v3, v3, v1, v2
    v_and_b32 v3, 0xff, v3
    v_cmp_ne_u32 s[12:13], 0, v3
    v_xor_b32 v1, s72, v116
    v_xor_b32 v2, s73, v117
    v_or_b32 v3, v1, v2
    v_xor_b32 v1, s74, v118
    v_xor_b32 v2, s75, v119
    v_or3_b32 v3, v3, v1, v2
    v_and_b32 v3, 0xff, v3
    v_cmp_ne_u32 s[14:15], 0, v3
    s_mov_b64 s[66:67], s[12:13]
    s_or_b64 s[66:67], s[66:67], s[14:15]
    s_cmp_eq_u64 s[66:67], 0
    s_cbranch_scc1 L_pdone3
    s_sub_u32 s58, s58, 1
    s_cmp_eq_u32 s58, 0
    s_cbranch_scc1 L_pdone3
    s_sleep 1
    s_branch L_poll3
L_pdone3:
L_adone:
    s_nop 1
    v_and_b32 v112, 0xffffff00, v112
    v_and_b32 v113, 0xffffff00, v113
    v_and_b32 v114, 0xffffff00, v114
    v_and_b32 v115, 0xffffff00, v115
    v_and_b32 v116, 0xffffff00, v116
    v_and_b32 v117, 0xffffff00, v117
    v_and_b32 v118, 0xffffff00, v118
    v_and_b32 v119, 0xffffff00, v119
    v_add_f32 v112, v112, v116
    v_add_f32 v113, v113, v117
    v_add_f32 v114, v114, v118
    v_add_f32 v115, v115, v119
    v_add_f32_dpp v112, v112, v112 row_ror:8 row_mask:0xf bank_mask:0xf
    v_add_f32_dpp v113, v113, v113 row_ror:8 row_mask:0xf bank_mask:0xf
    v_add_f32_dpp v114, v114, v114 row_ror:8 row_mask:0xf bank_mask:0xf
    v_add_f32_dpp v115, v115, v115 row_ror:8 row_mask:0xf bank_mask:0xf
    v_mov_b32 v116, v112
    v_mov_b32 v117, v113
    v_mov_b32 v118, v114
    v_mov_b32 v119, v115
    v_permlane16_swap_b32 v112, v116
    v_permlane16_swap_b32 v113, v117
    v_permlane16_swap_b32 v114, v118
    v_permlane16_swap_b32 v115, v119
    v_add_f32 v112, v112, v116
    v_add_f32 v113, v113, v117
    v_add_f32 v114, v114, v118
    v_add_f32 v115, v115, v119
    v_mov_b32 v116, v112
    v_mov_b32 v117, v113
    v_mov_b32 v118, v114
    v_mov_b32 v119, v115
    v_permlane32_swap_b32 v112, v116
    v_permlane32_swap_b32 v113, v117
    v_permlane32_swap_b32 v114, v118
    v_permlane32_swap_b32 v115, v119
    v_add_f32 v112, v112, v116
    v_add_f32 v113, v113, v117
    v_add_f32 v114, v114, v118
    v_add_f32 v115, v115, v119
    v_cvt_pk_bf16_f32 v16, v112, v112
    v_cvt_pk_bf16_f32 v17, v113, v113
    v_cvt_pk_bf16_f32 v18, v114, v114
    v_cvt_pk_bf16_f32 v19, v115, v115
    v_lshlrev_b32 v16, 16, v16
    v_lshlrev_b32 v17, 16, v17
    v_lshlrev_b32 v18, 16, v18
    v_lshlrev_b32 v19, 16, v19
    v_mul_f32 v16, v6, v16
    v_mul_f32 v17, v6, v17
    v_mul_f32 v18, v6, v18
    v_mul_f32 v19, v6, v19
    v_cvt_pk_bf16_f32 v16, v16, v16
    v_cvt_pk_bf16_f32 v17, v17, v17
    v_cvt_pk_bf16_f32 v18, v18, v18
    v_cvt_pk_bf16_f32 v19, v19, v19
    v_lshlrev_b32 v16, 16, v16
    v_lshlrev_b32 v17, 16, v17
    v_lshlrev_b32 v18, 16, v18
    v_lshlrev_b32 v19, 16, v19
    v_add_f32 v16, v16, v12
    v_add_f32 v17, v17, v13
    v_add_f32 v18, v18, v14
    v_add_f32 v19, v19, v15
    v_cvt_pk_bf16_f32 v20, v16, v17
    v_cvt_pk_bf16_f32 v21, v18, v19
    s_mov_b64 exec, 0xff
    buffer_store_dwordx2 v[20:21], v10, s[52:55], s34 offen
    s_cmp_lg_u32 s2, 0
    s_cbranch_scc1 L_aux0_done
    s_mov_b64 exec, 1
    buffer_store_dword v43, off, s[36:39], 0 offset:0 sc1
L_aux0_done:
    s_mov_b64 exec, -1
    s_endpgm
L_aux1:
    s_mov_b32 s40, s8
    s_and_b32 s41, s9, 0xffff
    s_mov_b32 s42, 16384
    s_mov_b32 s43, 0x20000
    s_mov_b32 s44, s20
    s_and_b32 s45, s21, 0xffff
    s_mov_b32 s46, 7340032
    s_mov_b32 s47, 0x20000
    s_mov_b32 s48, s22
    s_and_b32 s49, s23, 0xffff
    s_mov_b32 s50, 7340032
    s_mov_b32 s51, 0x20000
    s_mov_b32 s52, s24
    s_and_b32 s53, s25, 0xffff
    s_mov_b32 s54, 7340032
    s_mov_b32 s55, 0x20000
    s_and_b32 s57, s2, 7
    s_lshr_b32 s58, s2, 3
    s_add_u32 s59, s58, 1
    s_sub_u32 s6, s59, 28
    s_cmp_ge_u32 s59, 28
    s_cselect_b32 s59, s6, s59
    s_lshr_b32 s7, s57, 1
    s_and_b32 s6, s57, 1
    s_mul_i32 s6, s6, 28
    s_add_u32 s6, s6, s59
    s_lshl_b32 s57, s57, 2
    s_add_u32 s57, s57, s58
    s_sub_u32 s57, s57, 28
    s_and_b32 s59, s57, 7
    s_add_u32 s59, s59, 56
    s_lshr_b32 s57, s57, 3
    s_cmp_lt_u32 s58, 28
    s_cselect_b32 s6, s6, s59
    s_cselect_b32 s7, s7, s57
    s_cselect_b32 s46, s46, 0
    s_cselect_b32 s50, s50, 0
    s_mul_i32 s26, s7, 1835008
    s_lshl_b32 s57, s6, 7
    s_add_u32 s26, s26, s57
    s_lshl_b32 s70, s7, 9
    s_lshr_b32 s57, s6, 1
    s_lshl_b32 s57, s57, 14
    s_add_u32 s70, s70, s57
    s_and_b32 s57, s6, 1
    s_lshl_b32 s57, s57, 8
    s_add_u32 s70, s70, s57
    s_and_b32 s57, s2, 7
    s_lshr_b32 s58, s2, 3
    s_add_u32 s59, s58, 0
    s_sub_u32 s6, s59, 28
    s_cmp_ge_u32 s59, 28
    s_cselect_b32 s59, s6, s59
    s_lshr_b32 s7, s57, 1
    s_and_b32 s6, s57, 1
    s_mul_i32 s6, s6, 28
    s_add_u32 s6, s6, s59
    s_lshl_b32 s57, s57, 2
    s_add_u32 s57, s57, s58
    s_sub_u32 s57, s57, 28
    s_and_b32 s59, s57, 7
    s_add_u32 s59, s59, 56
    s_lshr_b32 s57, s57, 3
    s_cmp_lt_u32 s58, 28
    s_cselect_b32 s6, s6, s59
    s_cselect_b32 s7, s7, s57
    s_cselect_b32 s46, s46, 0
    s_cselect_b32 s50, s50, 0
    v_bfe_u32 v1, v0, 4, 1
    v_lshlrev_b32 v1, 1, v1
    v_and_b32 v2, 7, v0
    v_xor_b32 v2, v1, v2
    v_lshlrev_b32 v2, 4, v2
    v_lshrrev_b32 v1, 3, v0
    s_mov_b32 s57, 7168
    v_mul_lo_u32 v1, v1, s57
    v_add_u32 v176, v1, v2
    v_xor_b32 v2, 64, v2
    v_add_u32 v177, v1, v2
    s_mul_i32 s59, s7, 1835008
    s_lshl_b32 s57, s6, 7
    s_add_u32 s59, s59, s57
    s_lshl_b32 s69, s7, 9
    s_lshr_b32 s57, s6, 1
    s_lshl_b32 s57, s57, 14
    s_add_u32 s69, s69, s57
    s_and_b32 s57, s6, 1
    s_lshl_b32 s57, s57, 8
    s_add_u32 s69, s69, s57
    s_barrier
    buffer_load_dword v182, off, s[36:39], 0 offset:0 sc1
    v_and_b32 v181, 7, v0
    v_lshlrev_b32 v181, 11, v181
    v_lshrrev_b32 v1, 4, v0
    v_lshl_add_u32 v181, v1, 4, v181
    s_lshl_b32 s57, s7, 9
    buffer_load_dwordx4 v[8:11], v181, s[40:43], s57 offen offset:0
    buffer_load_dwordx4 v[12:15], v181, s[40:43], s57 offen offset:64
    buffer_load_dwordx4 v[16:19], v181, s[40:43], s57 offen offset:128
    buffer_load_dwordx4 v[20:23], v181, s[40:43], s57 offen offset:192
    buffer_load_dwordx4 v[24:27], v181, s[40:43], s57 offen offset:256
    buffer_load_dwordx4 v[28:31], v181, s[40:43], s57 offen offset:320
    buffer_load_dwordx4 v[32:35], v181, s[40:43], s57 offen offset:384
    buffer_load_dwordx4 v[36:39], v181, s[40:43], s57 offen offset:448
    s_mov_b32 m0, 32768
    s_add_u32 s57, s59, 0
    buffer_load_dwordx4 v176, s[44:47], s57 offen nt lds
    s_mov_b32 m0, 33792
    s_add_u32 s57, s59, 57344
    buffer_load_dwordx4 v177, s[44:47], s57 offen nt lds
    s_mov_b32 m0, 34816
    s_add_u32 s57, s59, 114688
    buffer_load_dwordx4 v176, s[44:47], s57 offen nt lds
    s_mov_b32 m0, 35840
    s_add_u32 s57, s59, 172032
    buffer_load_dwordx4 v177, s[44:47], s57 offen nt lds
    s_mov_b32 m0, 36864
    s_add_u32 s57, s59, 229376
    buffer_load_dwordx4 v176, s[44:47], s57 offen nt lds
    s_mov_b32 m0, 37888
    s_add_u32 s57, s59, 286720
    buffer_load_dwordx4 v177, s[44:47], s57 offen nt lds
    s_mov_b32 m0, 38912
    s_add_u32 s57, s59, 344064
    buffer_load_dwordx4 v176, s[44:47], s57 offen nt lds
    s_mov_b32 m0, 39936
    s_add_u32 s57, s59, 401408
    buffer_load_dwordx4 v177, s[44:47], s57 offen nt lds
    s_mov_b32 m0, 40960
    s_add_u32 s57, s59, 458752
    buffer_load_dwordx4 v176, s[44:47], s57 offen nt lds
    s_mov_b32 m0, 41984
    s_add_u32 s57, s59, 516096
    buffer_load_dwordx4 v177, s[44:47], s57 offen nt lds
    s_mov_b32 m0, 43008
    s_add_u32 s57, s59, 573440
    buffer_load_dwordx4 v176, s[44:47], s57 offen nt lds
    s_mov_b32 m0, 44032
    s_add_u32 s57, s59, 630784
    buffer_load_dwordx4 v177, s[44:47], s57 offen nt lds
    s_mov_b32 m0, 45056
    s_add_u32 s57, s59, 688128
    buffer_load_dwordx4 v176, s[44:47], s57 offen nt lds
    s_mov_b32 m0, 46080
    s_add_u32 s57, s59, 745472
    buffer_load_dwordx4 v177, s[44:47], s57 offen nt lds
    s_mov_b32 m0, 47104
    s_add_u32 s57, s59, 802816
    buffer_load_dwordx4 v176, s[44:47], s57 offen nt lds
    s_mov_b32 m0, 48128
    s_add_u32 s57, s59, 860160
    buffer_load_dwordx4 v177, s[44:47], s57 offen nt lds
    s_mov_b32 m0, 49152
    s_add_u32 s57, s59, 917504
    buffer_load_dwordx4 v176, s[44:47], s57 offen nt lds
    s_mov_b32 m0, 50176
    s_add_u32 s57, s59, 974848
    buffer_load_dwordx4 v177, s[44:47], s57 offen nt lds
    s_mov_b32 m0, 51200
    s_add_u32 s57, s59, 1032192
    buffer_load_dwordx4 v176, s[44:47], s57 offen nt lds
    s_mov_b32 m0, 52224
    s_add_u32 s57, s59, 1089536
    buffer_load_dwordx4 v177, s[44:47], s57 offen nt lds
    s_mov_b32 m0, 53248
    s_add_u32 s57, s59, 1146880
    buffer_load_dwordx4 v176, s[44:47], s57 offen nt lds
    s_mov_b32 m0, 54272
    s_add_u32 s57, s59, 1204224
    buffer_load_dwordx4 v177, s[44:47], s57 offen nt lds
    s_mov_b32 m0, 55296
    s_add_u32 s57, s59, 1261568
    buffer_load_dwordx4 v176, s[44:47], s57 offen nt lds
    s_mov_b32 m0, 56320
    s_add_u32 s57, s59, 1318912
    buffer_load_dwordx4 v177, s[44:47], s57 offen nt lds
    s_mov_b32 m0, 57344
    s_add_u32 s57, s59, 1376256
    buffer_load_dwordx4 v176, s[44:47], s57 offen nt lds
    s_mov_b32 m0, 58368
    s_add_u32 s57, s59, 1433600
    buffer_load_dwordx4 v177, s[44:47], s57 offen nt lds
    s_mov_b32 m0, 59392
    s_add_u32 s57, s59, 1490944
    buffer_load_dwordx4 v176, s[44:47], s57 offen nt lds
    s_mov_b32 m0, 60416
    s_add_u32 s57, s59, 1548288
    buffer_load_dwordx4 v177, s[44:47], s57 offen nt lds
    s_mov_b32 m0, 61440
    s_add_u32 s57, s59, 1605632
    buffer_load_dwordx4 v176, s[44:47], s57 offen nt lds
    s_mov_b32 m0, 62464
    s_add_u32 s57, s59, 1662976
    buffer_load_dwordx4 v177, s[44:47], s57 offen nt lds
    s_mov_b32 m0, 63488
    s_add_u32 s57, s59, 1720320
    buffer_load_dwordx4 v176, s[44:47], s57 offen nt lds
    s_mov_b32 m0, 64512
    s_add_u32 s57, s59, 1777664
    buffer_load_dwordx4 v177, s[44:47], s57 offen nt lds
    v_lshrrev_b32 v1, 4, v0
    v_bfe_u32 v2, v0, 2, 2
    v_lshl_add_u32 v178, v1, 3, v2
    v_lshlrev_b32 v178, 7, v178
    v_bfe_u32 v1, v0, 3, 2
    v_lshl_add_u32 v178, v1, 5, v178
    v_and_b32 v1, 3, v0
    v_lshl_add_u32 v178, v1, 3, v178
    v_add_u32 v178, 32768, v178
    v_add_u32 v175, 32768, v178
    v_and_b32 v180, 7, v0
    v_lshlrev_b32 v180, 11, v180
    v_bfe_u32 v1, v0, 3, 1
    v_lshl_add_u32 v180, v1, 6, v180
    v_lshrrev_b32 v1, 4, v0
    v_lshl_add_u32 v180, v1, 4, v180
    v_mov_b32 v183, 0xffffff00
    s_waitcnt vmcnt(40)
    v_readfirstlane_b32 s56, v182
    s_nop 0
    s_add_u32 s56, s56, 2654435769
    s_mov_b32 s72, s56
    s_lshr_b32 s73, s56, 8
    s_lshr_b32 s74, s56, 16
    s_lshr_b32 s75, s56, 24
    s_waitcnt vmcnt(31)
    s_mov_b32 m0, 65536
    s_add_u32 s57, s26, 0
    buffer_load_dwordx4 v176, s[48:51], s57 offen nt lds
    s_waitcnt vmcnt(31)
    s_mov_b32 m0, 66560
    s_add_u32 s57, s26, 57344
    buffer_load_dwordx4 v177, s[48:51], s57 offen nt lds
    s_waitcnt vmcnt(31)
    s_mov_b32 m0, 67584
    s_add_u32 s57, s26, 114688
    buffer_load_dwordx4 v176, s[48:51], s57 offen nt lds
    s_waitcnt vmcnt(31)
    s_mov_b32 m0, 68608
    s_add_u32 s57, s26, 172032
    buffer_load_dwordx4 v177, s[48:51], s57 offen nt lds
    s_waitcnt vmcnt(31)
    s_mov_b32 m0, 69632
    s_add_u32 s57, s26, 229376
    buffer_load_dwordx4 v176, s[48:51], s57 offen nt lds
    s_waitcnt vmcnt(31)
    s_mov_b32 m0, 70656
    s_add_u32 s57, s26, 286720
    buffer_load_dwordx4 v177, s[48:51], s57 offen nt lds
    s_waitcnt vmcnt(31)
    s_mov_b32 m0, 71680
    s_add_u32 s57, s26, 344064
    buffer_load_dwordx4 v176, s[48:51], s57 offen nt lds
    s_waitcnt vmcnt(31)
    s_mov_b32 m0, 72704
    s_add_u32 s57, s26, 401408
    buffer_load_dwordx4 v177, s[48:51], s57 offen nt lds
    s_waitcnt vmcnt(31)
    s_mov_b32 m0, 73728
    s_add_u32 s57, s26, 458752
    buffer_load_dwordx4 v176, s[48:51], s57 offen nt lds
    s_waitcnt vmcnt(31)
    s_mov_b32 m0, 74752
    s_add_u32 s57, s26, 516096
    buffer_load_dwordx4 v177, s[48:51], s57 offen nt lds
    s_waitcnt vmcnt(31)
    s_mov_b32 m0, 75776
    s_add_u32 s57, s26, 573440
    buffer_load_dwordx4 v176, s[48:51], s57 offen nt lds
    s_waitcnt vmcnt(31)
    s_mov_b32 m0, 76800
    s_add_u32 s57, s26, 630784
    buffer_load_dwordx4 v177, s[48:51], s57 offen nt lds
    s_waitcnt vmcnt(31)
    s_mov_b32 m0, 77824
    s_add_u32 s57, s26, 688128
    buffer_load_dwordx4 v176, s[48:51], s57 offen nt lds
    s_waitcnt vmcnt(31)
    s_mov_b32 m0, 78848
    s_add_u32 s57, s26, 745472
    buffer_load_dwordx4 v177, s[48:51], s57 offen nt lds
    s_waitcnt vmcnt(31)
    s_mov_b32 m0, 79872
    s_add_u32 s57, s26, 802816
    buffer_load_dwordx4 v176, s[48:51], s57 offen nt lds
    s_waitcnt vmcnt(31)
    s_mov_b32 m0, 80896
    s_add_u32 s57, s26, 860160
    buffer_load_dwordx4 v177, s[48:51], s57 offen nt lds
    s_waitcnt vmcnt(31)
    s_mov_b32 m0, 81920
    s_add_u32 s57, s26, 917504
    buffer_load_dwordx4 v176, s[48:51], s57 offen nt lds
    s_waitcnt vmcnt(31)
    s_mov_b32 m0, 82944
    s_add_u32 s57, s26, 974848
    buffer_load_dwordx4 v177, s[48:51], s57 offen nt lds
    s_waitcnt vmcnt(31)
    s_mov_b32 m0, 83968
    s_add_u32 s57, s26, 1032192
    buffer_load_dwordx4 v176, s[48:51], s57 offen nt lds
    s_waitcnt vmcnt(31)
    s_mov_b32 m0, 84992
    s_add_u32 s57, s26, 1089536
    buffer_load_dwordx4 v177, s[48:51], s57 offen nt lds
    s_waitcnt vmcnt(31)
    s_mov_b32 m0, 86016
    s_add_u32 s57, s26, 1146880
    buffer_load_dwordx4 v176, s[48:51], s57 offen nt lds
    s_waitcnt vmcnt(31)
    s_mov_b32 m0, 87040
    s_add_u32 s57, s26, 1204224
    buffer_load_dwordx4 v177, s[48:51], s57 offen nt lds
    s_waitcnt vmcnt(31)
    s_mov_b32 m0, 88064
    s_add_u32 s57, s26, 1261568
    buffer_load_dwordx4 v176, s[48:51], s57 offen nt lds
    s_waitcnt vmcnt(31)
    s_mov_b32 m0, 89088
    s_add_u32 s57, s26, 1318912
    buffer_load_dwordx4 v177, s[48:51], s57 offen nt lds
    s_waitcnt vmcnt(31)
    s_mov_b32 m0, 90112
    s_add_u32 s57, s26, 1376256
    buffer_load_dwordx4 v176, s[48:51], s57 offen nt lds
    s_waitcnt vmcnt(31)
    s_mov_b32 m0, 91136
    s_add_u32 s57, s26, 1433600
    buffer_load_dwordx4 v177, s[48:51], s57 offen nt lds
    s_waitcnt vmcnt(31)
    s_mov_b32 m0, 92160
    s_add_u32 s57, s26, 1490944
    buffer_load_dwordx4 v176, s[48:51], s57 offen nt lds
    s_waitcnt vmcnt(31)
    s_mov_b32 m0, 93184
    s_add_u32 s57, s26, 1548288
    buffer_load_dwordx4 v177, s[48:51], s57 offen nt lds
    s_waitcnt vmcnt(31)
    s_mov_b32 m0, 94208
    s_add_u32 s57, s26, 1605632
    buffer_load_dwordx4 v176, s[48:51], s57 offen nt lds
    s_waitcnt vmcnt(31)
    s_mov_b32 m0, 95232
    s_add_u32 s57, s26, 1662976
    buffer_load_dwordx4 v177, s[48:51], s57 offen nt lds
    s_waitcnt vmcnt(31)
    s_mov_b32 m0, 96256
    s_add_u32 s57, s26, 1720320
    buffer_load_dwordx4 v176, s[48:51], s57 offen nt lds
    s_waitcnt vmcnt(31)
    s_mov_b32 m0, 97280
    s_add_u32 s57, s26, 1777664
    buffer_load_dwordx4 v177, s[48:51], s57 offen nt lds
    s_add_u32 s70, s70, 3145728
    s_add_u32 s69, s69, 2097152
    v_bfe_u32 v1, v0, 4, 1
    v_lshlrev_b32 v1, 1, v1
    v_and_b32 v2, 7, v0
    v_xor_b32 v2, v1, v2
    v_lshlrev_b32 v2, 4, v2
    v_lshrrev_b32 v1, 3, v0
    s_mov_b32 s57, 2048
    v_mul_lo_u32 v1, v1, s57
    v_add_u32 v170, v1, v2
    v_xor_b32 v2, 64, v2
    v_add_u32 v171, v1, v2
    s_and_b32 s57, s2, 7
    s_lshr_b32 s58, s2, 3
    s_lshl_b32 s6, s57, 2
    s_add_u32 s6, s6, s58
    s_add_u32 s6, s6, 196
    s_mul_i32 s57, s57, 28
    s_add_u32 s57, s57, s58
    s_add_u32 s57, s57, 4
    s_sub_u32 s7, s57, 224
    s_cmp_ge_u32 s57, 224
    s_cselect_b32 s57, s7, s57
    s_cmp_lt_u32 s58, 28
    s_cselect_b32 s57, s57, s6
    s_lshr_b32 s6, s57, 4
    s_and_b32 s7, s57, 15
    s_lshl_b32 s27, s6, 19
    s_lshl_b32 s28, s6, 11
    s_lshl_b32 s58, s7, 7
    s_add_u32 s27, s27, s58
    s_lshl_b32 s58, s7, 15
    s_add_u32 s28, s28, s58
    s_waitcnt vmcnt(31)
    s_mov_b32 m0, 129024
    s_add_u32 s57, s27, 0
    buffer_load_dwordx4 v170, s[52:55], s57 offen nt lds
    s_waitcnt vmcnt(31)
    s_mov_b32 m0, 130048
    s_add_u32 s57, s27, 16384
    buffer_load_dwordx4 v171, s[52:55], s57 offen nt lds
    s_waitcnt vmcnt(31)
    s_mov_b32 m0, 131072
    s_add_u32 s57, s27, 32768
    buffer_load_dwordx4 v170, s[52:55], s57 offen nt lds
    s_waitcnt vmcnt(31)
    s_mov_b32 m0, 132096
    s_add_u32 s57, s27, 49152
    buffer_load_dwordx4 v171, s[52:55], s57 offen nt lds
    s_waitcnt vmcnt(31)
    s_mov_b32 m0, 133120
    s_add_u32 s57, s27, 65536
    buffer_load_dwordx4 v170, s[52:55], s57 offen nt lds
    s_waitcnt vmcnt(31)
    s_mov_b32 m0, 134144
    s_add_u32 s57, s27, 81920
    buffer_load_dwordx4 v171, s[52:55], s57 offen nt lds
    s_waitcnt vmcnt(31)
    s_mov_b32 m0, 135168
    s_add_u32 s57, s27, 98304
    buffer_load_dwordx4 v170, s[52:55], s57 offen nt lds
    s_waitcnt vmcnt(31)
    s_mov_b32 m0, 136192
    s_add_u32 s57, s27, 114688
    buffer_load_dwordx4 v171, s[52:55], s57 offen nt lds
    s_waitcnt vmcnt(31)
    s_mov_b32 m0, 137216
    s_add_u32 s57, s27, 131072
    buffer_load_dwordx4 v170, s[52:55], s57 offen nt lds
    s_waitcnt vmcnt(31)
    s_mov_b32 m0, 138240
    s_add_u32 s57, s27, 147456
    buffer_load_dwordx4 v171, s[52:55], s57 offen nt lds
    s_waitcnt vmcnt(31)
    s_mov_b32 m0, 139264
    s_add_u32 s57, s27, 163840
    buffer_load_dwordx4 v170, s[52:55], s57 offen nt lds
    s_waitcnt vmcnt(31)
    s_mov_b32 m0, 140288
    s_add_u32 s57, s27, 180224
    buffer_load_dwordx4 v171, s[52:55], s57 offen nt lds
    s_waitcnt vmcnt(31)
    s_mov_b32 m0, 141312
    s_add_u32 s57, s27, 196608
    buffer_load_dwordx4 v170, s[52:55], s57 offen nt lds
    s_waitcnt vmcnt(31)
    s_mov_b32 m0, 142336
    s_add_u32 s57, s27, 212992
    buffer_load_dwordx4 v171, s[52:55], s57 offen nt lds
    s_waitcnt vmcnt(31)
    s_mov_b32 m0, 143360
    s_add_u32 s57, s27, 229376
    buffer_load_dwordx4 v170, s[52:55], s57 offen nt lds
    s_waitcnt vmcnt(31)
    s_mov_b32 m0, 144384
    s_add_u32 s57, s27, 245760
    buffer_load_dwordx4 v171, s[52:55], s57 offen nt lds
    s_waitcnt vmcnt(31)
    s_mov_b32 m0, 145408
    s_add_u32 s57, s27, 262144
    buffer_load_dwordx4 v170, s[52:55], s57 offen nt lds
    s_waitcnt vmcnt(31)
    s_mov_b32 m0, 146432
    s_add_u32 s57, s27, 278528
    buffer_load_dwordx4 v171, s[52:55], s57 offen nt lds
    s_waitcnt vmcnt(31)
    s_mov_b32 m0, 147456
    s_add_u32 s57, s27, 294912
    buffer_load_dwordx4 v170, s[52:55], s57 offen nt lds
    s_waitcnt vmcnt(31)
    s_mov_b32 m0, 148480
    s_add_u32 s57, s27, 311296
    buffer_load_dwordx4 v171, s[52:55], s57 offen nt lds
    s_waitcnt vmcnt(31)
    s_mov_b32 m0, 149504
    s_add_u32 s57, s27, 327680
    buffer_load_dwordx4 v170, s[52:55], s57 offen nt lds
    s_waitcnt vmcnt(31)
    s_mov_b32 m0, 150528
    s_add_u32 s57, s27, 344064
    buffer_load_dwordx4 v171, s[52:55], s57 offen nt lds
    s_waitcnt vmcnt(31)
    s_mov_b32 m0, 151552
    s_add_u32 s57, s27, 360448
    buffer_load_dwordx4 v170, s[52:55], s57 offen nt lds
    s_waitcnt vmcnt(31)
    s_mov_b32 m0, 152576
    s_add_u32 s57, s27, 376832
    buffer_load_dwordx4 v171, s[52:55], s57 offen nt lds
    s_waitcnt vmcnt(31)
    s_mov_b32 m0, 153600
    s_add_u32 s57, s27, 393216
    buffer_load_dwordx4 v170, s[52:55], s57 offen nt lds
    s_waitcnt vmcnt(31)
    s_mov_b32 m0, 154624
    s_add_u32 s57, s27, 409600
    buffer_load_dwordx4 v171, s[52:55], s57 offen nt lds
    s_waitcnt vmcnt(31)
    s_mov_b32 m0, 155648
    s_add_u32 s57, s27, 425984
    buffer_load_dwordx4 v170, s[52:55], s57 offen nt lds
    s_waitcnt vmcnt(31)
    s_mov_b32 m0, 156672
    s_add_u32 s57, s27, 442368
    buffer_load_dwordx4 v171, s[52:55], s57 offen nt lds
    s_waitcnt vmcnt(31)
    s_mov_b32 m0, 157696
    s_add_u32 s57, s27, 458752
    buffer_load_dwordx4 v170, s[52:55], s57 offen nt lds
    s_waitcnt vmcnt(31)
    s_mov_b32 m0, 158720
    s_add_u32 s57, s27, 475136
    buffer_load_dwordx4 v171, s[52:55], s57 offen nt lds
    s_waitcnt vmcnt(31)
    s_mov_b32 m0, 159744
    s_add_u32 s57, s27, 491520
    buffer_load_dwordx4 v170, s[52:55], s57 offen nt lds
    s_waitcnt vmcnt(31)
    s_mov_b32 m0, 160768
    s_add_u32 s57, s27, 507904
    buffer_load_dwordx4 v171, s[52:55], s57 offen nt lds
    s_waitcnt vmcnt(63)
    v_xor_b32 v179, 0, v178
    ds_read_b64_tr_b16 v[40:41], v179 offset:0
    ds_read_b64_tr_b16 v[42:43], v179 offset:512
    ds_read_b64_tr_b16 v[44:45], v179 offset:4096
    ds_read_b64_tr_b16 v[46:47], v179 offset:4608
    ds_read_b64_tr_b16 v[48:49], v179 offset:8192
    ds_read_b64_tr_b16 v[50:51], v179 offset:8704
    ds_read_b64_tr_b16 v[52:53], v179 offset:12288
    ds_read_b64_tr_b16 v[54:55], v179 offset:12800
    s_waitcnt lgkmcnt(0)
    v_xor_b32 v179, 32, v178
    ds_read_b64_tr_b16 v[56:57], v179 offset:0
    ds_read_b64_tr_b16 v[58:59], v179 offset:512
    ds_read_b64_tr_b16 v[60:61], v179 offset:4096
    ds_read_b64_tr_b16 v[62:63], v179 offset:4608
    ds_read_b64_tr_b16 v[64:65], v179 offset:8192
    ds_read_b64_tr_b16 v[66:67], v179 offset:8704
    ds_read_b64_tr_b16 v[68:69], v179 offset:12288
    ds_read_b64_tr_b16 v[70:71], v179 offset:12800
    v_mfma_f32_16x16x32_bf16 v[72:75], v[40:43], v[8:11], 0
    v_mfma_f32_16x16x32_bf16 v[72:75], v[44:47], v[12:15], v[72:75]
    v_mfma_f32_16x16x32_bf16 v[72:75], v[48:51], v[16:19], v[72:75]
    v_mfma_f32_16x16x32_bf16 v[72:75], v[52:55], v[20:23], v[72:75]
    s_waitcnt lgkmcnt(0)
    v_xor_b32 v179, 64, v178
    ds_read_b64_tr_b16 v[40:41], v179 offset:0
    ds_read_b64_tr_b16 v[42:43], v179 offset:512
    ds_read_b64_tr_b16 v[44:45], v179 offset:4096
    ds_read_b64_tr_b16 v[46:47], v179 offset:4608
    ds_read_b64_tr_b16 v[48:49], v179 offset:8192
    ds_read_b64_tr_b16 v[50:51], v179 offset:8704
    ds_read_b64_tr_b16 v[52:53], v179 offset:12288
    ds_read_b64_tr_b16 v[54:55], v179 offset:12800
    v_mfma_f32_16x16x32_bf16 v[76:79], v[56:59], v[8:11], 0
    v_mfma_f32_16x16x32_bf16 v[76:79], v[60:63], v[12:15], v[76:79]
    v_mfma_f32_16x16x32_bf16 v[76:79], v[64:67], v[16:19], v[76:79]
    v_mfma_f32_16x16x32_bf16 v[76:79], v[68:71], v[20:23], v[76:79]
    s_waitcnt lgkmcnt(0)
    v_xor_b32 v179, 96, v178
    ds_read_b64_tr_b16 v[56:57], v179 offset:0
    ds_read_b64_tr_b16 v[58:59], v179 offset:512
    ds_read_b64_tr_b16 v[60:61], v179 offset:4096
    ds_read_b64_tr_b16 v[62:63], v179 offset:4608
    ds_read_b64_tr_b16 v[64:65], v179 offset:8192
    ds_read_b64_tr_b16 v[66:67], v179 offset:8704
    ds_read_b64_tr_b16 v[68:69], v179 offset:12288
    ds_read_b64_tr_b16 v[70:71], v179 offset:12800
    v_mfma_f32_16x16x32_bf16 v[80:83], v[40:43], v[8:11], 0
    v_mfma_f32_16x16x32_bf16 v[80:83], v[44:47], v[12:15], v[80:83]
    v_mfma_f32_16x16x32_bf16 v[80:83], v[48:51], v[16:19], v[80:83]
    v_mfma_f32_16x16x32_bf16 v[80:83], v[52:55], v[20:23], v[80:83]
    s_waitcnt lgkmcnt(0)
    s_waitcnt vmcnt(63)
    v_xor_b32 v179, 0, v178
    ds_read_b64_tr_b16 v[40:41], v179 offset:16384
    ds_read_b64_tr_b16 v[42:43], v179 offset:16896
    ds_read_b64_tr_b16 v[44:45], v179 offset:20480
    ds_read_b64_tr_b16 v[46:47], v179 offset:20992
    ds_read_b64_tr_b16 v[48:49], v179 offset:24576
    ds_read_b64_tr_b16 v[50:51], v179 offset:25088
    ds_read_b64_tr_b16 v[52:53], v179 offset:28672
    ds_read_b64_tr_b16 v[54:55], v179 offset:29184
    v_mfma_f32_16x16x32_bf16 v[84:87], v[56:59], v[8:11], 0
    v_mfma_f32_16x16x32_bf16 v[84:87], v[60:63], v[12:15], v[84:87]
    v_mfma_f32_16x16x32_bf16 v[84:87], v[64:67], v[16:19], v[84:87]
    v_mfma_f32_16x16x32_bf16 v[84:87], v[68:71], v[20:23], v[84:87]
    s_waitcnt lgkmcnt(0)
    v_xor_b32 v179, 32, v178
    ds_read_b64_tr_b16 v[56:57], v179 offset:16384
    ds_read_b64_tr_b16 v[58:59], v179 offset:16896
    ds_read_b64_tr_b16 v[60:61], v179 offset:20480
    ds_read_b64_tr_b16 v[62:63], v179 offset:20992
    ds_read_b64_tr_b16 v[64:65], v179 offset:24576
    ds_read_b64_tr_b16 v[66:67], v179 offset:25088
    ds_read_b64_tr_b16 v[68:69], v179 offset:28672
    ds_read_b64_tr_b16 v[70:71], v179 offset:29184
    v_mfma_f32_16x16x32_bf16 v[72:75], v[40:43], v[24:27], v[72:75]
    v_mfma_f32_16x16x32_bf16 v[72:75], v[44:47], v[28:31], v[72:75]
    v_mfma_f32_16x16x32_bf16 v[72:75], v[48:51], v[32:35], v[72:75]
    v_mfma_f32_16x16x32_bf16 v[72:75], v[52:55], v[36:39], v[72:75]
    s_waitcnt lgkmcnt(0)
    v_xor_b32 v179, 64, v178
    ds_read_b64_tr_b16 v[40:41], v179 offset:16384
    ds_read_b64_tr_b16 v[42:43], v179 offset:16896
    ds_read_b64_tr_b16 v[44:45], v179 offset:20480
    ds_read_b64_tr_b16 v[46:47], v179 offset:20992
    ds_read_b64_tr_b16 v[48:49], v179 offset:24576
    ds_read_b64_tr_b16 v[50:51], v179 offset:25088
    ds_read_b64_tr_b16 v[52:53], v179 offset:28672
    ds_read_b64_tr_b16 v[54:55], v179 offset:29184
    v_mfma_f32_16x16x32_bf16 v[76:79], v[56:59], v[24:27], v[76:79]
    v_mfma_f32_16x16x32_bf16 v[76:79], v[60:63], v[28:31], v[76:79]
    v_mfma_f32_16x16x32_bf16 v[76:79], v[64:67], v[32:35], v[76:79]
    v_mfma_f32_16x16x32_bf16 v[76:79], v[68:71], v[36:39], v[76:79]
    s_waitcnt lgkmcnt(0)
    v_xor_b32 v179, 96, v178
    ds_read_b64_tr_b16 v[56:57], v179 offset:16384
    ds_read_b64_tr_b16 v[58:59], v179 offset:16896
    ds_read_b64_tr_b16 v[60:61], v179 offset:20480
    ds_read_b64_tr_b16 v[62:63], v179 offset:20992
    ds_read_b64_tr_b16 v[64:65], v179 offset:24576
    ds_read_b64_tr_b16 v[66:67], v179 offset:25088
    ds_read_b64_tr_b16 v[68:69], v179 offset:28672
    ds_read_b64_tr_b16 v[70:71], v179 offset:29184
    v_mfma_f32_16x16x32_bf16 v[80:83], v[40:43], v[24:27], v[80:83]
    v_mfma_f32_16x16x32_bf16 v[80:83], v[44:47], v[28:31], v[80:83]
    v_mfma_f32_16x16x32_bf16 v[80:83], v[48:51], v[32:35], v[80:83]
    v_mfma_f32_16x16x32_bf16 v[80:83], v[52:55], v[36:39], v[80:83]
    s_waitcnt lgkmcnt(0)
    v_mfma_f32_16x16x32_bf16 v[84:87], v[56:59], v[24:27], v[84:87]
    v_mfma_f32_16x16x32_bf16 v[84:87], v[60:63], v[28:31], v[84:87]
    v_mfma_f32_16x16x32_bf16 v[84:87], v[64:67], v[32:35], v[84:87]
    v_mfma_f32_16x16x32_bf16 v[84:87], v[68:71], v[36:39], v[84:87]
    v_cndmask_b32 v72, v72, v76, s[60:61]
    v_cndmask_b32 v73, v73, v77, s[60:61]
    v_cndmask_b32 v74, v74, v78, s[60:61]
    v_cndmask_b32 v75, v75, v79, s[60:61]
    v_add_u32 v1, 0x80, v72
    v_bfi_b32 v88, v183, v1, s72
    v_add_u32 v1, 0x80, v73
    v_bfi_b32 v89, v183, v1, s73
    v_add_u32 v1, 0x80, v74
    v_bfi_b32 v90, v183, v1, s74
    v_add_u32 v1, 0x80, v75
    v_bfi_b32 v91, v183, v1, s75
    buffer_store_dwordx4 v[88:91], v180, s[36:39], s69 offen offset:0 sc1
    v_cndmask_b32 v80, v80, v84, s[60:61]
    v_cndmask_b32 v81, v81, v85, s[60:61]
    v_cndmask_b32 v82, v82, v86, s[60:61]
    v_cndmask_b32 v83, v83, v87, s[60:61]
    v_add_u32 v1, 0x80, v80
    v_bfi_b32 v92, v183, v1, s72
    v_add_u32 v1, 0x80, v81
    v_bfi_b32 v93, v183, v1, s73
    v_add_u32 v1, 0x80, v82
    v_bfi_b32 v94, v183, v1, s74
    v_add_u32 v1, 0x80, v83
    v_bfi_b32 v95, v183, v1, s75
    buffer_store_dwordx4 v[92:95], v180, s[36:39], s69 offen offset:128 sc1
    s_waitcnt vmcnt(50)
    v_xor_b32 v179, 0, v175
    ds_read_b64_tr_b16 v[40:41], v179 offset:0
    ds_read_b64_tr_b16 v[42:43], v179 offset:512
    ds_read_b64_tr_b16 v[44:45], v179 offset:4096
    ds_read_b64_tr_b16 v[46:47], v179 offset:4608
    ds_read_b64_tr_b16 v[48:49], v179 offset:8192
    ds_read_b64_tr_b16 v[50:51], v179 offset:8704
    ds_read_b64_tr_b16 v[52:53], v179 offset:12288
    ds_read_b64_tr_b16 v[54:55], v179 offset:12800
    s_waitcnt lgkmcnt(0)
    v_xor_b32 v179, 32, v175
    ds_read_b64_tr_b16 v[56:57], v179 offset:0
    ds_read_b64_tr_b16 v[58:59], v179 offset:512
    ds_read_b64_tr_b16 v[60:61], v179 offset:4096
    ds_read_b64_tr_b16 v[62:63], v179 offset:4608
    ds_read_b64_tr_b16 v[64:65], v179 offset:8192
    ds_read_b64_tr_b16 v[66:67], v179 offset:8704
    ds_read_b64_tr_b16 v[68:69], v179 offset:12288
    ds_read_b64_tr_b16 v[70:71], v179 offset:12800
    v_mfma_f32_16x16x32_bf16 v[72:75], v[40:43], v[8:11], 0
    v_mfma_f32_16x16x32_bf16 v[72:75], v[44:47], v[12:15], v[72:75]
    v_mfma_f32_16x16x32_bf16 v[72:75], v[48:51], v[16:19], v[72:75]
    v_mfma_f32_16x16x32_bf16 v[72:75], v[52:55], v[20:23], v[72:75]
    s_waitcnt lgkmcnt(0)
    v_xor_b32 v179, 64, v175
    ds_read_b64_tr_b16 v[40:41], v179 offset:0
    ds_read_b64_tr_b16 v[42:43], v179 offset:512
    ds_read_b64_tr_b16 v[44:45], v179 offset:4096
    ds_read_b64_tr_b16 v[46:47], v179 offset:4608
    ds_read_b64_tr_b16 v[48:49], v179 offset:8192
    ds_read_b64_tr_b16 v[50:51], v179 offset:8704
    ds_read_b64_tr_b16 v[52:53], v179 offset:12288
    ds_read_b64_tr_b16 v[54:55], v179 offset:12800
    v_mfma_f32_16x16x32_bf16 v[76:79], v[56:59], v[8:11], 0
    v_mfma_f32_16x16x32_bf16 v[76:79], v[60:63], v[12:15], v[76:79]
    v_mfma_f32_16x16x32_bf16 v[76:79], v[64:67], v[16:19], v[76:79]
    v_mfma_f32_16x16x32_bf16 v[76:79], v[68:71], v[20:23], v[76:79]
    s_waitcnt lgkmcnt(0)
    v_xor_b32 v179, 96, v175
    ds_read_b64_tr_b16 v[56:57], v179 offset:0
    ds_read_b64_tr_b16 v[58:59], v179 offset:512
    ds_read_b64_tr_b16 v[60:61], v179 offset:4096
    ds_read_b64_tr_b16 v[62:63], v179 offset:4608
    ds_read_b64_tr_b16 v[64:65], v179 offset:8192
    ds_read_b64_tr_b16 v[66:67], v179 offset:8704
    ds_read_b64_tr_b16 v[68:69], v179 offset:12288
    ds_read_b64_tr_b16 v[70:71], v179 offset:12800
    v_mfma_f32_16x16x32_bf16 v[80:83], v[40:43], v[8:11], 0
    v_mfma_f32_16x16x32_bf16 v[80:83], v[44:47], v[12:15], v[80:83]
    v_mfma_f32_16x16x32_bf16 v[80:83], v[48:51], v[16:19], v[80:83]
    v_mfma_f32_16x16x32_bf16 v[80:83], v[52:55], v[20:23], v[80:83]
    s_waitcnt lgkmcnt(0)
    s_waitcnt vmcnt(34)
    v_xor_b32 v179, 0, v175
    ds_read_b64_tr_b16 v[40:41], v179 offset:16384
    ds_read_b64_tr_b16 v[42:43], v179 offset:16896
    ds_read_b64_tr_b16 v[44:45], v179 offset:20480
    ds_read_b64_tr_b16 v[46:47], v179 offset:20992
    ds_read_b64_tr_b16 v[48:49], v179 offset:24576
    ds_read_b64_tr_b16 v[50:51], v179 offset:25088
    ds_read_b64_tr_b16 v[52:53], v179 offset:28672
    ds_read_b64_tr_b16 v[54:55], v179 offset:29184
    v_mfma_f32_16x16x32_bf16 v[84:87], v[56:59], v[8:11], 0
    v_mfma_f32_16x16x32_bf16 v[84:87], v[60:63], v[12:15], v[84:87]
    v_mfma_f32_16x16x32_bf16 v[84:87], v[64:67], v[16:19], v[84:87]
    v_mfma_f32_16x16x32_bf16 v[84:87], v[68:71], v[20:23], v[84:87]
    s_waitcnt lgkmcnt(0)
    v_xor_b32 v179, 32, v175
    ds_read_b64_tr_b16 v[56:57], v179 offset:16384
    ds_read_b64_tr_b16 v[58:59], v179 offset:16896
    ds_read_b64_tr_b16 v[60:61], v179 offset:20480
    ds_read_b64_tr_b16 v[62:63], v179 offset:20992
    ds_read_b64_tr_b16 v[64:65], v179 offset:24576
    ds_read_b64_tr_b16 v[66:67], v179 offset:25088
    ds_read_b64_tr_b16 v[68:69], v179 offset:28672
    ds_read_b64_tr_b16 v[70:71], v179 offset:29184
    v_mfma_f32_16x16x32_bf16 v[72:75], v[40:43], v[24:27], v[72:75]
    v_mfma_f32_16x16x32_bf16 v[72:75], v[44:47], v[28:31], v[72:75]
    v_mfma_f32_16x16x32_bf16 v[72:75], v[48:51], v[32:35], v[72:75]
    v_mfma_f32_16x16x32_bf16 v[72:75], v[52:55], v[36:39], v[72:75]
    s_waitcnt lgkmcnt(0)
    v_xor_b32 v179, 64, v175
    ds_read_b64_tr_b16 v[40:41], v179 offset:16384
    ds_read_b64_tr_b16 v[42:43], v179 offset:16896
    ds_read_b64_tr_b16 v[44:45], v179 offset:20480
    ds_read_b64_tr_b16 v[46:47], v179 offset:20992
    ds_read_b64_tr_b16 v[48:49], v179 offset:24576
    ds_read_b64_tr_b16 v[50:51], v179 offset:25088
    ds_read_b64_tr_b16 v[52:53], v179 offset:28672
    ds_read_b64_tr_b16 v[54:55], v179 offset:29184
    v_mfma_f32_16x16x32_bf16 v[76:79], v[56:59], v[24:27], v[76:79]
    v_mfma_f32_16x16x32_bf16 v[76:79], v[60:63], v[28:31], v[76:79]
    v_mfma_f32_16x16x32_bf16 v[76:79], v[64:67], v[32:35], v[76:79]
    v_mfma_f32_16x16x32_bf16 v[76:79], v[68:71], v[36:39], v[76:79]
    s_waitcnt lgkmcnt(0)
    v_xor_b32 v179, 96, v175
    ds_read_b64_tr_b16 v[56:57], v179 offset:16384
    ds_read_b64_tr_b16 v[58:59], v179 offset:16896
    ds_read_b64_tr_b16 v[60:61], v179 offset:20480
    ds_read_b64_tr_b16 v[62:63], v179 offset:20992
    ds_read_b64_tr_b16 v[64:65], v179 offset:24576
    ds_read_b64_tr_b16 v[66:67], v179 offset:25088
    ds_read_b64_tr_b16 v[68:69], v179 offset:28672
    ds_read_b64_tr_b16 v[70:71], v179 offset:29184
    v_mfma_f32_16x16x32_bf16 v[80:83], v[40:43], v[24:27], v[80:83]
    v_mfma_f32_16x16x32_bf16 v[80:83], v[44:47], v[28:31], v[80:83]
    v_mfma_f32_16x16x32_bf16 v[80:83], v[48:51], v[32:35], v[80:83]
    v_mfma_f32_16x16x32_bf16 v[80:83], v[52:55], v[36:39], v[80:83]
    s_waitcnt lgkmcnt(0)
    v_mfma_f32_16x16x32_bf16 v[84:87], v[56:59], v[24:27], v[84:87]
    v_mfma_f32_16x16x32_bf16 v[84:87], v[60:63], v[28:31], v[84:87]
    v_mfma_f32_16x16x32_bf16 v[84:87], v[64:67], v[32:35], v[84:87]
    v_mfma_f32_16x16x32_bf16 v[84:87], v[68:71], v[36:39], v[84:87]
    v_cndmask_b32 v72, v72, v76, s[60:61]
    v_cndmask_b32 v73, v73, v77, s[60:61]
    v_cndmask_b32 v74, v74, v78, s[60:61]
    v_cndmask_b32 v75, v75, v79, s[60:61]
    v_add_u32 v1, 0x80, v72
    v_bfi_b32 v96, v183, v1, s72
    v_add_u32 v1, 0x80, v73
    v_bfi_b32 v97, v183, v1, s73
    v_add_u32 v1, 0x80, v74
    v_bfi_b32 v98, v183, v1, s74
    v_add_u32 v1, 0x80, v75
    v_bfi_b32 v99, v183, v1, s75
    buffer_store_dwordx4 v[96:99], v180, s[36:39], s70 offen offset:0 sc1
    v_cndmask_b32 v80, v80, v84, s[60:61]
    v_cndmask_b32 v81, v81, v85, s[60:61]
    v_cndmask_b32 v82, v82, v86, s[60:61]
    v_cndmask_b32 v83, v83, v87, s[60:61]
    v_add_u32 v1, 0x80, v80
    v_bfi_b32 v100, v183, v1, s72
    v_add_u32 v1, 0x80, v81
    v_bfi_b32 v101, v183, v1, s73
    v_add_u32 v1, 0x80, v82
    v_bfi_b32 v102, v183, v1, s74
    v_add_u32 v1, 0x80, v83
    v_bfi_b32 v103, v183, v1, s75
    buffer_store_dwordx4 v[100:103], v180, s[36:39], s70 offen offset:128 sc1
    s_add_u32 s69, s28, 5242880
    v_lshrrev_b32 v1, 4, v0
    v_bfe_u32 v2, v0, 2, 2
    v_lshl_add_u32 v178, v1, 3, v2
    v_lshlrev_b32 v178, 7, v178
    v_bfe_u32 v1, v0, 3, 2
    v_lshl_add_u32 v178, v1, 5, v178
    v_and_b32 v1, 3, v0
    v_lshl_add_u32 v178, v1, 3, v178
    v_add_u32 v178, 129024, v178
    s_lshl_b32 s70, s5, 3
    s_add_u32 s70, s70, s4
    s_lshl_b32 s59, s70, 11
    s_add_u32 s71, s59, 3145728
    s_add_u32 s59, s59, 2097152
    v_lshlrev_b32 v181, 4, v0
    s_sleep 127
    s_mov_b32 s58, 200000
    s_mov_b64 s[8:9], -1
    s_mov_b64 s[10:11], -1
    s_mov_b64 s[12:13], -1
    s_mov_b64 s[14:15], -1
L_poll4:
    s_mov_b64 exec, s[8:9]
    s_cbranch_execz L_pskip4_0
    buffer_load_dwordx4 v[104:107], v181, s[36:39], s59 offen sc1
L_pskip4_0:
    s_mov_b64 exec, s[10:11]
    s_cbranch_execz L_pskip4_1
    buffer_load_dwordx4 v[108:111], v181, s[36:39], s59 offen offset:1024 sc1
L_pskip4_1:
    s_mov_b64 exec, s[12:13]
    s_cbranch_execz L_pskip4_2
    buffer_load_dwordx4 v[112:115], v181, s[36:39], s71 offen sc1
L_pskip4_2:
    s_mov_b64 exec, s[14:15]
    s_cbranch_execz L_pskip4_3
    buffer_load_dwordx4 v[116:119], v181, s[36:39], s71 offen offset:1024 sc1
L_pskip4_3:
    s_mov_b64 exec, -1
    s_waitcnt vmcnt(0)
    v_xor_b32 v1, s72, v104
    v_xor_b32 v2, s73, v105
    v_or_b32 v3, v1, v2
    v_xor_b32 v1, s74, v106
    v_xor_b32 v2, s75, v107
    v_or3_b32 v3, v3, v1, v2
    v_and_b32 v3, 0xff, v3
    v_cmp_ne_u32 s[8:9], 0, v3
    v_xor_b32 v1, s72, v108
    v_xor_b32 v2, s73, v109
    v_or_b32 v3, v1, v2
    v_xor_b32 v1, s74, v110
    v_xor_b32 v2, s75, v111
    v_or3_b32 v3, v3, v1, v2
    v_and_b32 v3, 0xff, v3
    v_cmp_ne_u32 s[10:11], 0, v3
    v_xor_b32 v1, s72, v112
    v_xor_b32 v2, s73, v113
    v_or_b32 v3, v1, v2
    v_xor_b32 v1, s74, v114
    v_xor_b32 v2, s75, v115
    v_or3_b32 v3, v3, v1, v2
    v_and_b32 v3, 0xff, v3
    v_cmp_ne_u32 s[12:13], 0, v3
    v_xor_b32 v1, s72, v116
    v_xor_b32 v2, s73, v117
    v_or_b32 v3, v1, v2
    v_xor_b32 v1, s74, v118
    v_xor_b32 v2, s75, v119
    v_or3_b32 v3, v3, v1, v2
    v_and_b32 v3, 0xff, v3
    v_cmp_ne_u32 s[14:15], 0, v3
    s_mov_b64 s[66:67], s[8:9]
    s_or_b64 s[66:67], s[66:67], s[10:11]
    s_or_b64 s[66:67], s[66:67], s[12:13]
    s_or_b64 s[66:67], s[66:67], s[14:15]
    s_cmp_eq_u64 s[66:67], 0
    s_cbranch_scc1 L_pdone4
    s_sub_u32 s58, s58, 1
    s_cmp_eq_u32 s58, 0
    s_cbranch_scc1 L_pdone4
    s_sleep 127
    s_branch L_poll4
L_pdone4:
    v_and_b32 v104, 0xffffff00, v104
    v_and_b32 v105, 0xffffff00, v105
    v_and_b32 v106, 0xffffff00, v106
    v_and_b32 v107, 0xffffff00, v107
    v_and_b32 v108, 0xffffff00, v108
    v_and_b32 v109, 0xffffff00, v109
    v_and_b32 v110, 0xffffff00, v110
    v_and_b32 v111, 0xffffff00, v111
    v_add_f32 v104, v104, v108
    v_add_f32 v105, v105, v109
    v_add_f32 v106, v106, v110
    v_add_f32 v107, v107, v111
    v_mov_b32 v1, v104
    s_nop 1
    v_permlane32_swap_b32 v104, v1
    v_add_f32 v104, v104, v1
    v_mov_b32 v1, v105
    s_nop 1
    v_permlane32_swap_b32 v105, v1
    v_add_f32 v105, v105, v1
    v_mov_b32 v1, v106
    s_nop 1
    v_permlane32_swap_b32 v106, v1
    v_add_f32 v106, v106, v1
    v_mov_b32 v1, v107
    s_nop 1
    v_permlane32_swap_b32 v107, v1
    v_add_f32 v107, v107, v1
    v_and_b32 v112, 0xffffff00, v112
    v_and_b32 v113, 0xffffff00, v113
    v_and_b32 v114, 0xffffff00, v114
    v_and_b32 v115, 0xffffff00, v115
    v_and_b32 v116, 0xffffff00, v116
    v_and_b32 v117, 0xffffff00, v117
    v_and_b32 v118, 0xffffff00, v118
    v_and_b32 v119, 0xffffff00, v119
    v_add_f32 v112, v112, v116
    v_add_f32 v113, v113, v117
    v_add_f32 v114, v114, v118
    v_add_f32 v115, v115, v119
    v_mov_b32 v1, v112
    s_nop 1
    v_permlane32_swap_b32 v112, v1
    v_add_f32 v112, v112, v1
    v_mov_b32 v1, v113
    s_nop 1
    v_permlane32_swap_b32 v113, v1
    v_add_f32 v113, v113, v1
    v_mov_b32 v1, v114
    s_nop 1
    v_permlane32_swap_b32 v114, v1
    v_add_f32 v114, v114, v1
    v_mov_b32 v1, v115
    s_nop 1
    v_permlane32_swap_b32 v115, v1
    v_add_f32 v115, v115, v1
    s_mov_b32 s59, 0x3d372713
    s_mov_b32 s71, 0x40135761
    v_cvt_pk_bf16_f32 v104, v104, v104
    v_lshlrev_b32 v104, 16, v104
    v_cvt_pk_bf16_f32 v112, v112, v112
    v_lshlrev_b32 v112, 16, v112
    v_mul_f32 v1, v104, v104
    v_mul_f32 v1, v1, v104
    v_fma_f32 v1, v1, s59, v104
    v_mul_f32 v1, s71, v1
    v_exp_f32 v1, -v1
    s_nop 0
    v_add_f32 v1, 1.0, v1
    v_rcp_f32 v1, v1
    s_nop 0
    v_mul_f32 v1, v104, v1
    v_cvt_pk_bf16_f32 v1, v1, v1
    v_lshlrev_b32 v1, 16, v1
    v_mul_f32 v104, v1, v112
    v_cvt_pk_bf16_f32 v105, v105, v105
    v_lshlrev_b32 v105, 16, v105
    v_cvt_pk_bf16_f32 v113, v113, v113
    v_lshlrev_b32 v113, 16, v113
    v_mul_f32 v1, v105, v105
    v_mul_f32 v1, v1, v105
    v_fma_f32 v1, v1, s59, v105
    v_mul_f32 v1, s71, v1
    v_exp_f32 v1, -v1
    s_nop 0
    v_add_f32 v1, 1.0, v1
    v_rcp_f32 v1, v1
    s_nop 0
    v_mul_f32 v1, v105, v1
    v_cvt_pk_bf16_f32 v1, v1, v1
    v_lshlrev_b32 v1, 16, v1
    v_mul_f32 v105, v1, v113
    v_cvt_pk_bf16_f32 v106, v106, v106
    v_lshlrev_b32 v106, 16, v106
    v_cvt_pk_bf16_f32 v114, v114, v114
    v_lshlrev_b32 v114, 16, v114
    v_mul_f32 v1, v106, v106
    v_mul_f32 v1, v1, v106
    v_fma_f32 v1, v1, s59, v106
    v_mul_f32 v1, s71, v1
    v_exp_f32 v1, -v1
    s_nop 0
    v_add_f32 v1, 1.0, v1
    v_rcp_f32 v1, v1
    s_nop 0
    v_mul_f32 v1, v106, v1
    v_cvt_pk_bf16_f32 v1, v1, v1
    v_lshlrev_b32 v1, 16, v1
    v_mul_f32 v106, v1, v114
    v_cvt_pk_bf16_f32 v107, v107, v107
    v_lshlrev_b32 v107, 16, v107
    v_cvt_pk_bf16_f32 v115, v115, v115
    v_lshlrev_b32 v115, 16, v115
    v_mul_f32 v1, v107, v107
    v_mul_f32 v1, v1, v107
    v_fma_f32 v1, v1, s59, v107
    v_mul_f32 v1, s71, v1
    v_exp_f32 v1, -v1
    s_nop 0
    v_add_f32 v1, 1.0, v1
    v_rcp_f32 v1, v1
    s_nop 0
    v_mul_f32 v1, v107, v1
    v_cvt_pk_bf16_f32 v1, v1, v1
    v_lshlrev_b32 v1, 16, v1
    v_mul_f32 v107, v1, v115
    v_cvt_pk_bf16_f32 v112, v104, v105
    v_cvt_pk_bf16_f32 v114, v106, v107
    v_mov_b32 v113, s56
    v_mov_b32 v115, s56
    s_lshl_b32 s70, s70, 9
    s_add_u32 s70, s70, 6291456
    s_mov_b32 s66, -1
    s_mov_b32 s67, 0
    s_mov_b64 exec, s[66:67]
    buffer_store_dwordx4 v[112:115], v181, s[36:39], s70 offen sc1
    s_mov_b64 exec, -1
    v_and_b32 v180, 7, v0
    v_lshlrev_b32 v180, 8, v180
    v_bfe_u32 v1, v0, 3, 1
    v_lshl_add_u32 v180, v1, 6, v180
    v_lshrrev_b32 v1, 4, v0
    v_lshl_add_u32 v180, v1, 4, v180
    s_lshl_b32 s59, s6, 13
    s_add_u32 s59, s59, 6291456
    s_add_u32 s71, s59, 4096
    v_lshrrev_b32 v1, 5, v0
    v_mul_u32_u24 v5, 272, v1
    v_and_b32 v1, 31, v0
    v_lshl_add_u32 v5, v1, 3, v5
    v_add_u32 v5, 108032, v5
    v_and_b32 v1, 7, v0
    v_mul_u32_u24 v6, 272, v1
    v_lshrrev_b32 v1, 4, v0
    v_lshl_add_u32 v6, v1, 4, v6
    v_add_u32 v6, 108032, v6
    s_sleep 127
    s_sleep 127
    s_mov_b32 s58, 200000
    s_mov_b64 s[8:9], -1
    s_mov_b64 s[10:11], -1
    s_mov_b64 s[12:13], -1
    s_mov_b64 s[14:15], -1
    s_mov_b64 s[16:17], -1
    s_mov_b64 s[18:19], -1
    s_mov_b64 s[20:21], -1
    s_mov_b64 s[22:23], -1
L_poll5:
    s_mov_b64 exec, s[8:9]
    s_cbranch_execz L_pskip5_0
    buffer_load_dwordx4 v[104:107], v181, s[36:39], s59 offen offset:0 sc1
L_pskip5_0:
    s_mov_b64 exec, s[10:11]
    s_cbranch_execz L_pskip5_1
    buffer_load_dwordx4 v[108:111], v181, s[36:39], s59 offen offset:1024 sc1
L_pskip5_1:
    s_mov_b64 exec, s[12:13]
    s_cbranch_execz L_pskip5_2
    buffer_load_dwordx4 v[112:115], v181, s[36:39], s59 offen offset:2048 sc1
L_pskip5_2:
    s_mov_b64 exec, s[14:15]
    s_cbranch_execz L_pskip5_3
    buffer_load_dwordx4 v[116:119], v181, s[36:39], s59 offen offset:3072 sc1
L_pskip5_3:
    s_mov_b64 exec, s[16:17]
    s_cbranch_execz L_pskip5_4
    buffer_load_dwordx4 v[120:123], v181, s[36:39], s71 offen offset:0 sc1
L_pskip5_4:
    s_mov_b64 exec, s[18:19]
    s_cbranch_execz L_pskip5_5
    buffer_load_dwordx4 v[124:127], v181, s[36:39], s71 offen offset:1024 sc1
L_pskip5_5:
    s_mov_b64 exec, s[20:21]
    s_cbranch_execz L_pskip5_6
    buffer_load_dwordx4 v[128:131], v181, s[36:39], s71 offen offset:2048 sc1
L_pskip5_6:
    s_mov_b64 exec, s[22:23]
    s_cbranch_execz L_pskip5_7
    buffer_load_dwordx4 v[132:135], v181, s[36:39], s71 offen offset:3072 sc1
L_pskip5_7:
    s_mov_b64 exec, -1
    s_waitcnt vmcnt(0)
    v_xor_b32 v1, s56, v105
    v_xor_b32 v2, s56, v107
    v_or_b32 v3, v1, v2
    v_cmp_ne_u32 s[8:9], 0, v3
    v_xor_b32 v1, s56, v109
    v_xor_b32 v2, s56, v111
    v_or_b32 v3, v1, v2
    v_cmp_ne_u32 s[10:11], 0, v3
    v_xor_b32 v1, s56, v113
    v_xor_b32 v2, s56, v115
    v_or_b32 v3, v1, v2
    v_cmp_ne_u32 s[12:13], 0, v3
    v_xor_b32 v1, s56, v117
    v_xor_b32 v2, s56, v119
    v_or_b32 v3, v1, v2
    v_cmp_ne_u32 s[14:15], 0, v3
    v_xor_b32 v1, s56, v121
    v_xor_b32 v2, s56, v123
    v_or_b32 v3, v1, v2
    v_cmp_ne_u32 s[16:17], 0, v3
    v_xor_b32 v1, s56, v125
    v_xor_b32 v2, s56, v127
    v_or_b32 v3, v1, v2
    v_cmp_ne_u32 s[18:19], 0, v3
    v_xor_b32 v1, s56, v129
    v_xor_b32 v2, s56, v131
    v_or_b32 v3, v1, v2
    v_cmp_ne_u32 s[20:21], 0, v3
    v_xor_b32 v1, s56, v133
    v_xor_b32 v2, s56, v135
    v_or_b32 v3, v1, v2
    v_cmp_ne_u32 s[22:23], 0, v3
    s_mov_b64 s[66:67], s[8:9]
    s_or_b64 s[66:67], s[66:67], s[10:11]
    s_or_b64 s[66:67], s[66:67], s[12:13]
    s_or_b64 s[66:67], s[66:67], s[14:15]
    s_or_b64 s[66:67], s[66:67], s[16:17]
    s_or_b64 s[66:67], s[66:67], s[18:19]
    s_or_b64 s[66:67], s[66:67], s[20:21]
    s_or_b64 s[66:67], s[66:67], s[22:23]
    s_cmp_eq_u64 s[66:67], 0
    s_cbranch_scc1 L_pdone5
    s_sub_u32 s58, s58, 1
    s_cmp_eq_u32 s58, 0
    s_cbranch_scc1 L_pdone5
    s_sleep 127
    s_branch L_poll5
L_pdone5:
    v_mov_b32 v105, v106
    ds_write_b64 v5, v[104:105] offset:0
    v_mov_b32 v109, v110
    ds_write_b64 v5, v[108:109] offset:544
    v_mov_b32 v113, v114
    ds_write_b64 v5, v[112:113] offset:1088
    v_mov_b32 v117, v118
    ds_write_b64 v5, v[116:117] offset:1632
    v_mov_b32 v121, v122
    ds_write_b64 v5, v[120:121] offset:2176
    v_mov_b32 v125, v126
    ds_write_b64 v5, v[124:125] offset:2720
    v_mov_b32 v129, v130
    ds_write_b64 v5, v[128:129] offset:3264
    v_mov_b32 v133, v134
    ds_write_b64 v5, v[132:133] offset:3808
    s_waitcnt lgkmcnt(0)
    ds_read_b128 v[8:11], v6 offset:0
    ds_read_b128 v[12:15], v6 offset:64
    ds_read_b128 v[16:19], v6 offset:128
    ds_read_b128 v[20:23], v6 offset:192
    ds_read_b128 v[24:27], v6 offset:2176
    ds_read_b128 v[28:31], v6 offset:2240
    ds_read_b128 v[32:35], v6 offset:2304
    ds_read_b128 v[36:39], v6 offset:2368
    s_waitcnt lgkmcnt(0)
    v_xor_b32 v179, 0, v178
    ds_read_b64_tr_b16 v[40:41], v179 offset:0
    ds_read_b64_tr_b16 v[42:43], v179 offset:512
    ds_read_b64_tr_b16 v[44:45], v179 offset:4096
    ds_read_b64_tr_b16 v[46:47], v179 offset:4608
    ds_read_b64_tr_b16 v[48:49], v179 offset:8192
    ds_read_b64_tr_b16 v[50:51], v179 offset:8704
    ds_read_b64_tr_b16 v[52:53], v179 offset:12288
    ds_read_b64_tr_b16 v[54:55], v179 offset:12800
    s_waitcnt lgkmcnt(0)
    v_xor_b32 v179, 32, v178
    ds_read_b64_tr_b16 v[56:57], v179 offset:0
    ds_read_b64_tr_b16 v[58:59], v179 offset:512
    ds_read_b64_tr_b16 v[60:61], v179 offset:4096
    ds_read_b64_tr_b16 v[62:63], v179 offset:4608
    ds_read_b64_tr_b16 v[64:65], v179 offset:8192
    ds_read_b64_tr_b16 v[66:67], v179 offset:8704
    ds_read_b64_tr_b16 v[68:69], v179 offset:12288
    ds_read_b64_tr_b16 v[70:71], v179 offset:12800
    v_mfma_f32_16x16x32_bf16 v[72:75], v[40:43], v[8:11], 0
    v_mfma_f32_16x16x32_bf16 v[72:75], v[44:47], v[12:15], v[72:75]
    v_mfma_f32_16x16x32_bf16 v[72:75], v[48:51], v[16:19], v[72:75]
    v_mfma_f32_16x16x32_bf16 v[72:75], v[52:55], v[20:23], v[72:75]
    s_waitcnt lgkmcnt(0)
    v_xor_b32 v179, 64, v178
    ds_read_b64_tr_b16 v[40:41], v179 offset:0
    ds_read_b64_tr_b16 v[42:43], v179 offset:512
    ds_read_b64_tr_b16 v[44:45], v179 offset:4096
    ds_read_b64_tr_b16 v[46:47], v179 offset:4608
    ds_read_b64_tr_b16 v[48:49], v179 offset:8192
    ds_read_b64_tr_b16 v[50:51], v179 offset:8704
    ds_read_b64_tr_b16 v[52:53], v179 offset:12288
    ds_read_b64_tr_b16 v[54:55], v179 offset:12800
    v_mfma_f32_16x16x32_bf16 v[76:79], v[56:59], v[8:11], 0
    v_mfma_f32_16x16x32_bf16 v[76:79], v[60:63], v[12:15], v[76:79]
    v_mfma_f32_16x16x32_bf16 v[76:79], v[64:67], v[16:19], v[76:79]
    v_mfma_f32_16x16x32_bf16 v[76:79], v[68:71], v[20:23], v[76:79]
    s_waitcnt lgkmcnt(0)
    v_xor_b32 v179, 96, v178
    ds_read_b64_tr_b16 v[56:57], v179 offset:0
    ds_read_b64_tr_b16 v[58:59], v179 offset:512
    ds_read_b64_tr_b16 v[60:61], v179 offset:4096
    ds_read_b64_tr_b16 v[62:63], v179 offset:4608
    ds_read_b64_tr_b16 v[64:65], v179 offset:8192
    ds_read_b64_tr_b16 v[66:67], v179 offset:8704
    ds_read_b64_tr_b16 v[68:69], v179 offset:12288
    ds_read_b64_tr_b16 v[70:71], v179 offset:12800
    v_mfma_f32_16x16x32_bf16 v[80:83], v[40:43], v[8:11], 0
    v_mfma_f32_16x16x32_bf16 v[80:83], v[44:47], v[12:15], v[80:83]
    v_mfma_f32_16x16x32_bf16 v[80:83], v[48:51], v[16:19], v[80:83]
    v_mfma_f32_16x16x32_bf16 v[80:83], v[52:55], v[20:23], v[80:83]
    s_waitcnt lgkmcnt(0)
    v_xor_b32 v179, 0, v178
    ds_read_b64_tr_b16 v[40:41], v179 offset:16384
    ds_read_b64_tr_b16 v[42:43], v179 offset:16896
    ds_read_b64_tr_b16 v[44:45], v179 offset:20480
    ds_read_b64_tr_b16 v[46:47], v179 offset:20992
    ds_read_b64_tr_b16 v[48:49], v179 offset:24576
    ds_read_b64_tr_b16 v[50:51], v179 offset:25088
    ds_read_b64_tr_b16 v[52:53], v179 offset:28672
    ds_read_b64_tr_b16 v[54:55], v179 offset:29184
    v_mfma_f32_16x16x32_bf16 v[84:87], v[56:59], v[8:11], 0
    v_mfma_f32_16x16x32_bf16 v[84:87], v[60:63], v[12:15], v[84:87]
    v_mfma_f32_16x16x32_bf16 v[84:87], v[64:67], v[16:19], v[84:87]
    v_mfma_f32_16x16x32_bf16 v[84:87], v[68:71], v[20:23], v[84:87]
    s_waitcnt lgkmcnt(0)
    v_xor_b32 v179, 32, v178
    ds_read_b64_tr_b16 v[56:57], v179 offset:16384
    ds_read_b64_tr_b16 v[58:59], v179 offset:16896
    ds_read_b64_tr_b16 v[60:61], v179 offset:20480
    ds_read_b64_tr_b16 v[62:63], v179 offset:20992
    ds_read_b64_tr_b16 v[64:65], v179 offset:24576
    ds_read_b64_tr_b16 v[66:67], v179 offset:25088
    ds_read_b64_tr_b16 v[68:69], v179 offset:28672
    ds_read_b64_tr_b16 v[70:71], v179 offset:29184
    v_mfma_f32_16x16x32_bf16 v[72:75], v[40:43], v[24:27], v[72:75]
    v_mfma_f32_16x16x32_bf16 v[72:75], v[44:47], v[28:31], v[72:75]
    v_mfma_f32_16x16x32_bf16 v[72:75], v[48:51], v[32:35], v[72:75]
    v_mfma_f32_16x16x32_bf16 v[72:75], v[52:55], v[36:39], v[72:75]
    s_waitcnt lgkmcnt(0)
    v_xor_b32 v179, 64, v178
    ds_read_b64_tr_b16 v[40:41], v179 offset:16384
    ds_read_b64_tr_b16 v[42:43], v179 offset:16896
    ds_read_b64_tr_b16 v[44:45], v179 offset:20480
    ds_read_b64_tr_b16 v[46:47], v179 offset:20992
    ds_read_b64_tr_b16 v[48:49], v179 offset:24576
    ds_read_b64_tr_b16 v[50:51], v179 offset:25088
    ds_read_b64_tr_b16 v[52:53], v179 offset:28672
    ds_read_b64_tr_b16 v[54:55], v179 offset:29184
    v_mfma_f32_16x16x32_bf16 v[76:79], v[56:59], v[24:27], v[76:79]
    v_mfma_f32_16x16x32_bf16 v[76:79], v[60:63], v[28:31], v[76:79]
    v_mfma_f32_16x16x32_bf16 v[76:79], v[64:67], v[32:35], v[76:79]
    v_mfma_f32_16x16x32_bf16 v[76:79], v[68:71], v[36:39], v[76:79]
    s_waitcnt lgkmcnt(0)
    v_xor_b32 v179, 96, v178
    ds_read_b64_tr_b16 v[56:57], v179 offset:16384
    ds_read_b64_tr_b16 v[58:59], v179 offset:16896
    ds_read_b64_tr_b16 v[60:61], v179 offset:20480
    ds_read_b64_tr_b16 v[62:63], v179 offset:20992
    ds_read_b64_tr_b16 v[64:65], v179 offset:24576
    ds_read_b64_tr_b16 v[66:67], v179 offset:25088
    ds_read_b64_tr_b16 v[68:69], v179 offset:28672
    ds_read_b64_tr_b16 v[70:71], v179 offset:29184
    v_mfma_f32_16x16x32_bf16 v[80:83], v[40:43], v[24:27], v[80:83]
    v_mfma_f32_16x16x32_bf16 v[80:83], v[44:47], v[28:31], v[80:83]
    v_mfma_f32_16x16x32_bf16 v[80:83], v[48:51], v[32:35], v[80:83]
    v_mfma_f32_16x16x32_bf16 v[80:83], v[52:55], v[36:39], v[80:83]
    s_waitcnt lgkmcnt(0)
    v_mfma_f32_16x16x32_bf16 v[84:87], v[56:59], v[24:27], v[84:87]
    v_mfma_f32_16x16x32_bf16 v[84:87], v[60:63], v[28:31], v[84:87]
    v_mfma_f32_16x16x32_bf16 v[84:87], v[64:67], v[32:35], v[84:87]
    v_mfma_f32_16x16x32_bf16 v[84:87], v[68:71], v[36:39], v[84:87]
    v_cndmask_b32 v72, v72, v76, s[60:61]
    v_cndmask_b32 v73, v73, v77, s[60:61]
    v_cndmask_b32 v74, v74, v78, s[60:61]
    v_cndmask_b32 v75, v75, v79, s[60:61]
    v_add_u32 v1, 0x80, v72
    v_bfi_b32 v88, v183, v1, s72
    v_add_u32 v1, 0x80, v73
    v_bfi_b32 v89, v183, v1, s73
    v_add_u32 v1, 0x80, v74
    v_bfi_b32 v90, v183, v1, s74
    v_add_u32 v1, 0x80, v75
    v_bfi_b32 v91, v183, v1, s75
    v_cndmask_b32 v80, v80, v84, s[60:61]
    v_cndmask_b32 v81, v81, v85, s[60:61]
    v_cndmask_b32 v82, v82, v86, s[60:61]
    v_cndmask_b32 v83, v83, v87, s[60:61]
    v_add_u32 v1, 0x80, v80
    v_bfi_b32 v92, v183, v1, s72
    v_add_u32 v1, 0x80, v81
    v_bfi_b32 v93, v183, v1, s73
    v_add_u32 v1, 0x80, v82
    v_bfi_b32 v94, v183, v1, s74
    v_add_u32 v1, 0x80, v83
    v_bfi_b32 v95, v183, v1, s75
    v_mov_b32 v1, 98568
    s_mov_b32 s58, 3200000
L_lwait:
    ds_read_b32 v2, v1
    s_waitcnt lgkmcnt(0)
    v_readfirstlane_b32 s57, v2
    s_nop 0
    s_cmp_lg_u32 s57, 0
    s_cbranch_scc1 L_lok
    s_sub_u32 s58, s58, 1
    s_cmp_eq_u32 s58, 0
    s_cbranch_scc1 L_lok
    s_sleep 8
    s_branch L_lwait
L_lok:
    buffer_store_dwordx4 v[88:91], v180, s[36:39], s69 offen offset:0 sc1
    buffer_store_dwordx4 v[92:95], v180, s[36:39], s69 offen offset:128 sc1
L_end:
    s_endpgm
.section .rodata,"a"
.p2align 6
.amdhsa_kernel gated_mix__mha_block_cached__geglu_ffn__decode_kernel
  .amdhsa_next_free_vgpr 192
  .amdhsa_next_free_sgpr 102
  .amdhsa_accum_offset 192
  .amdhsa_group_segment_fixed_size 0
  .amdhsa_kernarg_size 104
  .amdhsa_user_sgpr_count 2
  .amdhsa_user_sgpr_kernarg_segment_ptr 1
  .amdhsa_system_sgpr_workgroup_id_x 1
.end_amdhsa_kernel
```
